```python
import torch

def _softmax(x, axis=-1):
    return torch.softmax(x, dim=axis)
def _gelu(x):
    return torch.nn.functional.gelu(x, approximate="tanh")
def _silu(x):
    return torch.nn.functional.silu(x)
def _sigmoid(x):
    return torch.sigmoid(x)
def _layernorm(x, axis=-1, eps=1e-5):
    m = x.mean(dim=axis, keepdim=True)
    v = x.var(dim=axis, keepdim=True, unbiased=False)
    return (x - m) / torch.sqrt(v + eps)
def _scatter_add(tgt, idx, src, axis=0):
    return tgt.clone().index_add_(axis, idx, src)
def _segment_sum(src, seg, n):
    out = torch.zeros((n,) + src.shape[1:], dtype=src.dtype)
    return out.index_add_(0, seg, src)
def _pad(x, pw):
    flat = tuple(v for pair in reversed(pw) for v in pair)
    return torch.nn.functional.pad(x, flat)

kernel_name = 'recurrent_scan__gqa_block_cached__mixer_channel_mlp__decode'

def setup_inputs():

    _w = (lambda a: (lambda t: t.to(torch.bfloat16) if t.is_floating_point() else t)(torch.as_tensor(a)))
    def _A_setup():
        B, Sq, D = 2, 1, 1024
        Hq, Hkv, Sk, Dh = 32, 4, 16384, 128
        assert Hq % Hkv == 0, (Hq, Hkv)
        return {
            "x": _w((lambda *s: torch.randn(*s, dtype=torch.bfloat16) * 0.1)(B, Sq, D)),
            "k_cache": _w((lambda *s: torch.randn(*s, dtype=torch.bfloat16) * 0.8)(B, Hkv, Sk, Dh)),
            "v_cache": _w((lambda *s: torch.randn(*s, dtype=torch.bfloat16) * 3.2)(B, Hkv, Sk, Dh)),
            "wq": _w((lambda *s: torch.randn(*s, dtype=torch.bfloat16) * 0.8)(D, Hq * Dh) * (D ** -0.5)),
            "wo": _w((lambda *s: torch.randn(*s, dtype=torch.bfloat16) * 3.2)(Hq * Dh, D) * ((Hq * Dh) ** -0.5)),
        }
    _A_in = _A_setup()

    def _B_setup():
        B, S, D, F = 2, 1, 1024, 3584
        return {
            "x": _w((lambda *s: torch.randn(*s, dtype=torch.bfloat16) * 0.1)(B, S, D)),
            "w1": _w((lambda *s: torch.randn(*s, dtype=torch.bfloat16) * 3.2)(D, F) * (D ** -0.5)),
            "b1": _w((lambda *s: torch.randn(*s, dtype=torch.bfloat16) * 3.2)(F)),
            "w2": _w((lambda *s: torch.randn(*s, dtype=torch.bfloat16) * 3.2)(F, D) * (F ** -0.5)),
            "b2": _w((lambda *s: torch.randn(*s, dtype=torch.bfloat16) * 3.2)(D)),
        }
    _B_in = _B_setup()

    return {
        "A_x": _A_in["x"],
        "A_k_cache": _A_in["k_cache"],
        "A_v_cache": _A_in["v_cache"],
        "A_wq": _A_in["wq"],
        "A_wo": _A_in["wo"],
        "B_x": _B_in["x"],
        "B_w1": _B_in["w1"],
        "B_b1": _B_in["b1"],
        "B_w2": _B_in["w2"],
        "B_b2": _B_in["b2"],
    }

def reference(A_x, A_k_cache, A_v_cache, A_wq, A_wo, B_x, B_w1, B_b1, B_w2, B_b2):
    def _A_ref(x, k_cache, v_cache, wq, wo):
        B, Sq, D = x.shape
        Hq, Dh = 32, 128
        Hkv = k_cache.shape[1]
        rep = Hq // Hkv
        q = (lambda x, *d: x.permute(*d))((x @ wq).reshape(B, Sq, Hq, Dh), 0, 2, 1, 3)
        k = (lambda x, n, axis: torch.repeat_interleave(x, n, dim=axis))(k_cache, rep, axis=1)
        v = (lambda x, n, axis: torch.repeat_interleave(x, n, dim=axis))(v_cache, rep, axis=1)
        scores = torch.einsum("bhqd,bhkd->bhqk", q, k) * (Dh ** -0.5)
        p = _softmax(scores, axis=-1)
        o = torch.einsum("bhqk,bhkd->bhqd", p, v)
        return (lambda x, *d: x.permute(*d))(o, 0, 2, 1, 3).reshape(B, Sq, Hq * Dh) @ wo

    def _B_ref(x, w1, b1, w2, b2):
        y = _layernorm(x, axis=-1)
        h = _gelu(torch.einsum("bsd,df->bsf", y, w1) + b1)
        return torch.einsum("bsf,fd->bsd", h, w2) + b2

    x = A_x
    xn = _layernorm(x, axis=-1)
    s = _A_ref(xn, A_k_cache, A_v_cache, A_wq, A_wo)
    g = _silu(_B_ref(xn, B_w1, B_b1, B_w2, B_b2))
    return x + s * g
```

```asm
; @launch grid=(256,1,1) block=(1024,1,1) lds=152384
.amdgcn_target "amdgcn-amd-amdhsa--gfx950"
.text
.globl recurrent_scan__gqa_block_cached__mixer_channel_mlp__decode_kernel
.p2align 8
.type recurrent_scan__gqa_block_cached__mixer_channel_mlp__decode_kernel,@function
recurrent_scan__gqa_block_cached__mixer_channel_mlp__decode_kernel:
    s_load_dwordx2 s[44:45], s[0:1], 24
    s_getpc_b64 s[42:43]
    v_lshlrev_b32 v1, 4, v0
    global_load_dword v127, v1, s[42:43]
    v_lshrrev_b32 v2, 6, v0
    s_and_b32 s4, s2, 7
    v_readfirstlane_b32 s3, v2
    s_lshr_b32 s5, s2, 3
    s_cmp_ge_u32 s5, 32
    s_nop 1
    s_cbranch_scc1 L_end
    v_bfe_u32 v2, v0, 4, 2
    v_and_b32 v3, 15, v0
    s_and_b32 s99, s5, 3
    s_lshr_b32 s13, s5, 2
    s_and_b32 s6, s3, 3
    s_mov_b32 s47, 0x20000
    s_lshl_b32 s8, s13, 7
    s_lshl_b32 s10, s6, 5
    s_add_u32 s8, s8, s10
    s_cmp_ge_u32 s3, 4
    s_cbranch_scc1 L_ptrs
    s_add_u32 s14, s4, 1
    s_and_b32 s14, s14, 3
    s_lshl_b32 s14, s14, 3
    s_and_b32 s11, s4, 4
    s_add_u32 s14, s14, s11
    s_add_u32 s14, s14, s99
    s_lshl_b32 s10, s8, 13
    s_lshl_b32 s11, s14, 8
    s_add_u32 s10, s10, s11
    s_lshl_b32 s46, 1, 23
    s_movk_i32 s9, 0x2000
    v_lshlrev_b32 v6, 16, v2
    v_lshl_add_u32 v6, v3, 4, v6
    s_waitcnt lgkmcnt(0)
    buffer_load_dwordx4 v[64:67], v6, s[44:47], s10 offen nt
    s_add_u32 s10, s10, s9
    buffer_load_dwordx4 v[68:71], v6, s[44:47], s10 offen nt
    s_add_u32 s10, s10, s9
    buffer_load_dwordx4 v[72:75], v6, s[44:47], s10 offen nt
    s_add_u32 s10, s10, s9
    buffer_load_dwordx4 v[76:79], v6, s[44:47], s10 offen nt
    s_add_u32 s10, s10, s9
    buffer_load_dwordx4 v[80:83], v6, s[44:47], s10 offen nt
    s_add_u32 s10, s10, s9
    buffer_load_dwordx4 v[84:87], v6, s[44:47], s10 offen nt
    s_add_u32 s10, s10, s9
    buffer_load_dwordx4 v[88:91], v6, s[44:47], s10 offen nt
    s_add_u32 s10, s10, s9
    buffer_load_dwordx4 v[92:95], v6, s[44:47], s10 offen nt
L_ptrs:
    s_load_dwordx16 s[16:31], s[0:1], 0
    s_load_dwordx8 s[32:39], s[0:1], 64
    s_load_dwordx2 s[40:41], s[0:1], 96
    v_and_b32 v10, 32, v0
    v_lshlrev_b32 v10, 6, v10
    v_and_b32 v11, 31, v0
    v_lshl_add_u32 v10, v11, 4, v10
    s_cmp_lg_u32 s3, 0
    s_cbranch_scc1 L_rest
    s_waitcnt lgkmcnt(0)
    global_load_dwordx4 v[40:43], v10, s[16:17] offset:0
    global_load_dwordx4 v[44:47], v10, s[16:17] offset:512
    global_load_dwordx4 v[48:51], v10, s[16:17] offset:1024
    global_load_dwordx4 v[52:55], v10, s[16:17] offset:1536
L_rest:
    v_and_b32 v1, 63, v0
    v_mov_b32 v4, 152256
    s_mov_b32 s15, 0xffff0000
    v_mov_b32 v5, 0
    v_and_b32 v11, 31, v0
    v_lshl_add_u32 v11, v11, 2, v4
    ds_write_b32 v11, v5
    s_mov_b32 s51, 0x20000
    s_mov_b32 s54, 2490368
    s_mov_b32 s55, 0x20000
    s_cmp_ge_u32 s3, 8
    s_cbranch_scc1 L_attn
    s_lshr_b32 s7, s3, 2
    s_cbranch_scc1 L_side1
    s_waitcnt lgkmcnt(0)
    s_mov_b32 s12, 1
    s_mov_b32 s48, s24
    s_mov_b32 s49, s25
    s_mov_b32 s50, 0x800000
    s_waitcnt lgkmcnt(0)
    s_barrier
    s_branch L_now
L_side1:
    s_lshr_b32 s14, s4, 1
    s_mul_i32 s14, s14, 7
    s_and_b32 s10, s4, 1
    s_lshl_b32 s11, s10, 2
    s_add_u32 s14, s14, s11
    s_add_u32 s14, s14, s99
    s_min_u32 s11, s99, s10
    s_sub_u32 s14, s14, s11
    s_lshl_b32 s11, s10, 2
    s_add_u32 s11, s11, s99
    s_cmp_lg_u32 s11, 5
    s_cselect_b32 s12, 1, 0
    s_movk_i32 s9, 7168
    s_mov_b32 s46, 0x700000
    s_mov_b32 s50, s46
    v_mul_u32_u24 v6, 57344, v2
    v_lshl_add_u32 v6, v3, 4, v6
    s_mul_i32 s10, s8, s9
    s_lshl_b32 s11, s14, 8
    s_add_u32 s10, s10, s11
    v_and_b32 v10, 32, v0
    v_lshlrev_b32 v10, 6, v10
    v_and_b32 v11, 31, v0
    v_lshl_add_u32 v10, v11, 4, v10
    s_waitcnt lgkmcnt(0)
    s_mov_b32 s44, s28
    s_mov_b32 s45, s29
    s_mov_b32 s48, s32
    s_mov_b32 s49, s33
    s_barrier
    s_mov_b32 s94, s10
    s_cmp_eq_u32 s12, 0
    s_cbranch_scc1 L_now
    buffer_load_dwordx4 v[64:67], v6, s[44:47], s10 offen nt
    s_add_u32 s10, s10, s9
    buffer_load_dwordx4 v[68:71], v6, s[44:47], s10 offen nt
    s_add_u32 s10, s10, s9
    buffer_load_dwordx4 v[72:75], v6, s[44:47], s10 offen nt
    s_add_u32 s10, s10, s9
    buffer_load_dwordx4 v[76:79], v6, s[44:47], s10 offen nt
    s_add_u32 s10, s10, s9
    buffer_load_dwordx4 v[80:83], v6, s[44:47], s10 offen nt
    s_add_u32 s10, s10, s9
    buffer_load_dwordx4 v[84:87], v6, s[44:47], s10 offen nt
    s_add_u32 s10, s10, s9
    buffer_load_dwordx4 v[88:91], v6, s[44:47], s10 offen nt
    s_add_u32 s10, s10, s9
    buffer_load_dwordx4 v[92:95], v6, s[44:47], s10 offen nt
L_now:
    v_mov_b32 v5, 1
    s_mov_b64 exec, 1
    ds_add_u32 v4, v5 offset:76
    s_mov_b64 exec, -1
    s_load_dword s96, s[40:41], 0
    s_and_b32 s49, s49, 0xffff
    s_mov_b32 s52, s40
    s_and_b32 s53, s41, 0xffff
    s_lshl_b32 s10, s7, 2
    v_add_u32 v12, s10, v4
    s_cmp_lg_u32 s3, 2
    s_cbranch_scc1 L_nowarm
    s_call_b64 s[60:61], F_ln
L_nowarm:
    s_cmp_eq_u32 s12, 0
    s_cbranch_scc1 L_common
    s_cmp_lg_u32 s6, 0
    s_cbranch_scc1 L_common
    v_add_u32 v10, 131072, v10
    s_cmp_eq_u32 s7, 0
    s_cbranch_scc0 L_lny
    s_waitcnt vmcnt(0)
    s_branch L_ln0
L_lny:
    s_mov_b32 s63, 0
L_sp1:
    ds_read_b32 v5, v4 offset:8
    s_add_u32 s63, s63, 1
    s_waitcnt lgkmcnt(0)
    v_readfirstlane_b32 s62, v5
    s_nop 0
    s_cmp_ge_u32 s62, 1
    s_nop 1
    s_cbranch_scc1 L_sd2
    s_sleep 1
    s_cmp_lt_u32 s63, 0x200000
    s_cbranch_scc1 L_sp1
L_sd2:
    ds_read_b128 v[40:43], v10 offset:0
    ds_read_b128 v[44:47], v10 offset:512
    ds_read_b128 v[48:51], v10 offset:1024
    ds_read_b128 v[52:55], v10 offset:1536
    v_add_u32 v10, 4096, v10
L_ln0:
    s_waitcnt vmcnt(8) lgkmcnt(0)
    s_call_b64 s[60:61], F_ln
    ds_write_b128 v10, v[40:43] offset:0
    ds_write_b128 v10, v[44:47] offset:512
    ds_write_b128 v10, v[48:51] offset:1024
    ds_write_b128 v10, v[52:55] offset:1536
    v_mov_b32 v5, 1
    s_waitcnt lgkmcnt(0)
    ds_write_b32 v12, v5 offset:8
L_common:
    s_lshl_b32 s43, s14, 3
    s_add_u32 s43, s43, s13
    s_lshl_b32 s43, s43, 10
    s_cmp_eq_u32 s7, 0
    s_mov_b32 s42, 819200
    s_cselect_b32 s42, 327680, s42
    s_mov_b32 s39, 589824
    s_cselect_b32 s39, 65536, s39
    s_lshl_b32 s10, s2, 10
    s_cmp_eq_u32 s7, 0
    s_cselect_b32 s10, s10, s43
    s_add_u32 s42, s42, s10
    s_add_u32 s43, s43, s39
    v_and_b32 v11, 7, v3
    v_lshrrev_b32 v10, 1, v11
    v_and_b32 v11, 1, v11
    v_cmp_eq_u32 vcc, 1, v11
    v_mov_b32 v13, 0x0c0c0100
    v_mov_b32 v14, 0x01000c0c
    v_cndmask_b32 v13, v13, v14, vcc
    v_mov_b32 v14, 0x0c0c0302
    v_mov_b32 v15, 0x03020c0c
    v_cndmask_b32 v14, v14, v15, vcc
    v_mov_b32 v15, 0x0c0c0c0c
    v_cmp_eq_u32 vcc, 0, v10
    s_nop 1
    v_cndmask_b32 v16, v15, v13, vcc
    v_cndmask_b32 v17, v15, v14, vcc
    v_cmp_eq_u32 vcc, 1, v10
    s_nop 1
    v_cndmask_b32 v18, v15, v13, vcc
    v_cndmask_b32 v19, v15, v14, vcc
    v_cmp_eq_u32 vcc, 2, v10
    s_nop 1
    v_cndmask_b32 v20, v15, v13, vcc
    v_cndmask_b32 v21, v15, v14, vcc
    v_cmp_eq_u32 vcc, 3, v10
    s_nop 1
    v_cndmask_b32 v22, v15, v13, vcc
    v_cndmask_b32 v23, v15, v14, vcc
    v_lshrrev_b32 v11, 1, v2
    v_lshlrev_b32 v8, 9, v11
    v_lshl_add_u32 v8, v3, 5, v8
    v_and_b32 v11, 1, v2
    v_lshl_add_u32 v8, v11, 4, v8
    v_lshlrev_b32 v7, 4, v1
    s_lshl_b32 s10, s7, 12
    s_add_u32 s10, s10, 139264
    v_add_u32 v9, s10, v7
    s_lshl_b32 s10, s3, 10
    s_add_u32 s10, s10, 139264
    v_add_u32 v8, s10, v8
    s_lshl_b32 s10, s6, 7
    s_add_u32 s10, s10, 150144
    v_lshlrev_b32 v13, 2, v11
    v_and_b32 v11, 7, v3
    v_lshl_add_u32 v61, v11, 3, v13
    v_lshrrev_b32 v13, 5, v1
    v_lshl_add_u32 v13, v13, 6, v61
    v_add_u32 v13, s10, v13
    v_lshrrev_b32 v62, 3, v1
    v_lshlrev_b32 v62, 10, v62
    v_lshl_add_u32 v62, v11, 4, v62
    v_lshrrev_b32 v11, 3, v3
    v_lshlrev_b32 v14, 6, v11
    v_lshl_add_u32 v14, v2, 4, v14
    v_add_u32 v14, s10, v14
    s_lshl_b32 s10, s7, 12
    s_lshl_b32 s11, s8, 1
    s_add_u32 s10, s10, s11
    s_add_u32 s10, s10, 131072
    v_lshlrev_b32 v10, 11, v11
    v_lshl_add_u32 v10, v2, 4, v10
    v_add_u32 v10, s10, v10
    s_waitcnt lgkmcnt(0)
    s_add_u32 s97, s96, 0x1b3
    s_and_b32 s97, s97, 1023
    s_mov_b32 s98, 0xfffffc00
    v_mov_b32 v15, s97
    s_mov_b32 s34, 1
    s_cmp_lg_u32 s3, 3
    s_cbranch_scc1 L_nogw
    s_mov_b32 s32, 0
    v_add_u32 v12, 124, v4
    s_nop 0
    s_call_b64 s[60:61], F_gemv
    v_mov_b32 v12, v4
L_nogw:
    s_mov_b32 s32, 1
    s_cmp_eq_u32 s12, 0
    s_cbranch_scc1 L_nomlp
    s_mov_b32 s63, 0
L_sp3:
    ds_read_b32 v5, v12 offset:8
    s_add_u32 s63, s63, 1
    s_waitcnt lgkmcnt(0)
    v_readfirstlane_b32 s62, v5
    s_nop 0
    s_cmp_ge_u32 s62, 1
    s_nop 1
    s_cbranch_scc1 L_sd4
    s_sleep 1
    s_cmp_lt_u32 s63, 0x200000
    s_cbranch_scc1 L_sp3
L_sd4:
    ds_read_b128 v[24:27], v10
    s_mov_b32 s10, s43
    s_xor_b32 s38, s7, 1
    s_waitcnt vmcnt(0)
    s_call_b64 s[60:61], F_gemv
    s_mov_b32 s38, 1
    s_cmp_lg_u32 s7, 0
    s_cbranch_scc1 L_mlp
    s_cmp_lg_u32 s11, 3
    s_cbranch_scc1 L_hopb
    s_and_b32 s10, s4, 3
    s_lshl_b32 s10, s10, 16
    s_lshl_b32 s11, s13, 13
    s_add_u32 s10, s10, s11
    s_lshr_b32 s11, s4, 2
    s_lshl_b32 s11, s11, 9
    s_add_u32 s10, s10, s11
    s_lshl_b32 s11, s99, 7
    s_add_u32 s10, s10, s11
    s_add_u32 s88, s10, 65536
    s_mov_b32 s37, 0
    s_mov_b32 s36, s37
    buffer_load_dwordx4 v[96:99], v62, s[52:55], s88 offen sc1
    s_sleep 6
    buffer_load_dwordx4 v[100:103], v62, s[52:55], s88 offen sc1
L_pa:
    s_waitcnt vmcnt(1)
    v_xor_b32 v48, s97, v96
    v_xor_b32 v49, s97, v97
    v_xor_b32 v50, s97, v98
    v_xor_b32 v51, s97, v99
    v_or3_b32 v56, v48, v49, v50
    v_or_b32 v56, v56, v51
    v_and_b32 v56, 1023, v56
    v_cmp_ne_u32 s[8:9], 0, v56
    s_nop 0
    s_cmp_eq_u64 s[8:9], 0
    s_nop 1
    s_cbranch_scc1 L_pad
    buffer_load_dwordx4 v[96:99], v62, s[52:55], s88 offen sc1
    s_waitcnt vmcnt(1)
    v_xor_b32 v48, s97, v100
    v_xor_b32 v49, s97, v101
    v_xor_b32 v50, s97, v102
    v_xor_b32 v51, s97, v103
    v_or3_b32 v56, v48, v49, v50
    v_or_b32 v56, v56, v51
    v_and_b32 v56, 1023, v56
    v_cmp_ne_u32 s[8:9], 0, v56
    s_nop 0
    s_cmp_eq_u64 s[8:9], 0
    s_nop 1
    s_cbranch_scc1 L_pad
    buffer_load_dwordx4 v[100:103], v62, s[52:55], s88 offen sc1
    s_add_u32 s36, s36, 1
    s_and_b32 s62, s36, 255
    s_cbranch_scc1 L_rs5
    s_mov_b64 exec, -1
    buffer_wbl2 sc1
    s_waitcnt vmcnt(0)
    buffer_inv sc1
    s_waitcnt vmcnt(0)
L_rs5:
    s_cmp_lt_u32 s36, 65536
    s_cbranch_scc1 L_pa
L_pad:
    s_lshl_b32 s10, s4, 12
    s_lshl_b32 s11, s5, 7
    s_add_u32 s10, s10, s11
    s_add_u32 s23, s10, 2097152
    s_mov_b32 s34, 2
    s_call_b64 s[60:61], F_red32
    v_mov_b32 v5, 1
    ds_write_b32 v4, v5 offset:16
L_hopb:
    s_mov_b32 s34, 1
    v_lshrrev_b32 v10, 5, v1
    v_and_b32 v11, 31, v1
    v_mov_b32 v62, v7
    s_lshl_b32 s10, s4, 12
    s_lshl_b32 s11, s6, 10
    s_add_u32 s10, s10, s11
    s_add_u32 s88, s10, 2097152
    v_mul_u32_u24 v60, 272, v10
    v_lshl_add_u32 v60, v11, 3, v60
    s_mul_i32 s10, s6, 544
    s_add_u32 s10, s10, 147456
    v_add_u32 v60, s10, v60
    s_mov_b32 s63, 0
L_sp6:
    ds_read_b32 v5, v4 offset:16
    s_add_u32 s63, s63, 1
    s_waitcnt lgkmcnt(0)
    v_readfirstlane_b32 s62, v5
    s_nop 0
    s_cmp_ge_u32 s62, 1
    s_nop 1
    s_cbranch_scc1 L_sd7
    s_sleep 2
    s_cmp_lt_u32 s63, 0x200000
    s_cbranch_scc1 L_sp6
L_sd7:
    s_mov_b32 s37, 0
    s_mov_b32 s36, s37
    buffer_load_dwordx4 v[96:99], v62, s[52:55], s88 offen sc1
    s_sleep 6
    buffer_load_dwordx4 v[100:103], v62, s[52:55], s88 offen sc1
L_pb:
    s_waitcnt vmcnt(1)
    v_xor_b32 v48, s97, v96
    v_xor_b32 v49, s97, v97
    v_xor_b32 v50, s97, v98
    v_xor_b32 v51, s97, v99
    v_or3_b32 v56, v48, v49, v50
    v_or_b32 v56, v56, v51
    v_and_b32 v56, 1023, v56
    v_cmp_ne_u32 s[8:9], 0, v56
    s_nop 0
    s_cmp_eq_u64 s[8:9], 0
    s_nop 1
    s_cbranch_scc1 L_pbd
    buffer_load_dwordx4 v[96:99], v62, s[52:55], s88 offen sc1
    s_waitcnt vmcnt(1)
    v_xor_b32 v48, s97, v100
    v_xor_b32 v49, s97, v101
    v_xor_b32 v50, s97, v102
    v_xor_b32 v51, s97, v103
    v_or3_b32 v56, v48, v49, v50
    v_or_b32 v56, v56, v51
    v_and_b32 v56, 1023, v56
    v_cmp_ne_u32 s[8:9], 0, v56
    s_nop 0
    s_cmp_eq_u64 s[8:9], 0
    s_nop 1
    s_cbranch_scc1 L_pbd
    buffer_load_dwordx4 v[100:103], v62, s[52:55], s88 offen sc1
    s_add_u32 s36, s36, 1
    s_and_b32 s62, s36, 255
    s_cbranch_scc1 L_rs8
    s_mov_b64 exec, -1
    buffer_wbl2 sc1
    s_waitcnt vmcnt(0)
    buffer_inv sc1
    s_waitcnt vmcnt(0)
L_rs8:
    s_cmp_lt_u32 s36, 65536
    s_cbranch_scc1 L_pb
L_pbd:
    v_cvt_pk_bf16_f32 v48, v48, v49
    v_cvt_pk_bf16_f32 v49, v50, v51
    ds_write_b64 v60, v[48:49]
    s_waitcnt lgkmcnt(0)
    v_mov_b32 v5, 1
    s_mov_b64 exec, 1
    ds_add_u32 v4, v5 offset:24
    s_mov_b64 exec, -1
    v_lshlrev_b32 v6, 12, v2
    v_lshl_add_u32 v6, v3, 4, v6
    s_lshl_b32 s10, s5, 18
    s_lshl_b32 s11, s6, 16
    s_add_u32 s10, s10, s11
    s_lshl_b32 s11, s4, 8
    s_add_u32 s10, s10, s11
    s_mov_b32 s63, 0
L_sp9:
    ds_read_b32 v5, v4 offset:92
    s_add_u32 s63, s63, 1
    s_waitcnt lgkmcnt(0)
    v_readfirstlane_b32 s62, v5
    s_nop 0
    s_cmp_ge_u32 s62, 1
    s_nop 1
    s_cbranch_scc1 L_sd10
    s_sleep 1
    s_cmp_lt_u32 s63, 0x200000
    s_cbranch_scc1 L_sp9
L_sd10:
    s_add_u32 s11, s10, 0
    buffer_load_dwordx4 v[64:67], v6, s[48:51], s11 offen nt
    s_add_u32 s11, s10, 16384
    buffer_load_dwordx4 v[68:71], v6, s[48:51], s11 offen nt
    s_add_u32 s11, s10, 32768
    buffer_load_dwordx4 v[72:75], v6, s[48:51], s11 offen nt
    s_add_u32 s11, s10, 49152
    buffer_load_dwordx4 v[76:79], v6, s[48:51], s11 offen nt
    s_mov_b32 s63, 0
L_sp11:
    ds_read_b32 v5, v4 offset:44
    s_add_u32 s63, s63, 1
    s_waitcnt lgkmcnt(0)
    v_readfirstlane_b32 s62, v5
    s_nop 0
    s_cmp_ge_u32 s62, 1
    s_nop 1
    s_cbranch_scc1 L_sd12
    s_sleep 1
    s_cmp_lt_u32 s63, 0x200000
    s_cbranch_scc1 L_sp11
L_sd12:
    s_add_u32 s11, s10, 2048
    buffer_load_dwordx4 v[80:83], v6, s[48:51], s11 offen nt
    s_add_u32 s11, s10, 18432
    buffer_load_dwordx4 v[84:87], v6, s[48:51], s11 offen nt
    s_add_u32 s11, s10, 34816
    buffer_load_dwordx4 v[88:91], v6, s[48:51], s11 offen nt
    s_add_u32 s11, s10, 51200
    buffer_load_dwordx4 v[92:95], v6, s[48:51], s11 offen nt
    s_setprio 2
L_hop2:
    v_lshrrev_b32 v62, 3, v3
    s_lshr_b32 s10, s5, 3
    v_lshl_add_u32 v5, v62, 2, s10
    v_cmp_eq_u32 vcc, s4, v5
    v_mov_b32 v5, 32768
    s_nop 0
    v_cndmask_b32 v5, 0, v5, vcc
    v_lshl_add_u32 v62, v62, 9, v5
    v_lshl_add_u32 v62, v2, 5, v62
    s_lshl_b32 s10, s5, 10
    s_lshl_b32 s11, s6, 7
    s_add_u32 s10, s10, s11
    s_add_u32 s88, s10, 2129920
    s_add_u32 s89, s88, 16
    s_mov_b32 s38, 0
    s_mov_b32 s63, 0
L_sp13:
    ds_read_b32 v5, v4 offset:44
    s_add_u32 s63, s63, 1
    s_waitcnt lgkmcnt(0)
    v_readfirstlane_b32 s62, v5
    s_nop 0
    s_cmp_ge_u32 s62, 1
    s_nop 1
    s_cbranch_scc1 L_sd14
    s_sleep 1
    s_cmp_lt_u32 s63, 0x200000
    s_cbranch_scc1 L_sp13
L_sd14:
    s_mov_b32 s10, s42
    s_mov_b32 s37, 0
    s_call_b64 s[60:61], F_hop2
    v_mov_b32 v5, 1
    s_mov_b64 exec, 1
    ds_add_u32 v4, v5 offset:52
    s_mov_b64 exec, -1
    s_branch L_fin
F_g4:
    s_mov_b32 s36, s37
    buffer_load_dwordx4 v[64:67], v21, s[52:55], s88 offen sc1
    buffer_load_dwordx4 v[68:71], v21, s[52:55], s89 offen sc1
    buffer_load_dwordx4 v[72:75], v21, s[52:55], s90 offen sc1
    buffer_load_dwordx4 v[76:79], v21, s[52:55], s91 offen sc1
    s_sleep 3
    buffer_load_dwordx4 v[80:83], v21, s[52:55], s88 offen sc1
    buffer_load_dwordx4 v[84:87], v21, s[52:55], s89 offen sc1
    buffer_load_dwordx4 v[88:91], v21, s[52:55], s90 offen sc1
    buffer_load_dwordx4 v[92:95], v21, s[52:55], s91 offen sc1
L_g4:
    s_waitcnt vmcnt(4)
    v_xor_b32 v24, s97, v64
    v_xor_b32 v25, s97, v65
    v_xor_b32 v26, s97, v66
    v_xor_b32 v27, s97, v67
    v_xor_b32 v28, s97, v68
    v_xor_b32 v29, s97, v69
    v_xor_b32 v30, s97, v70
    v_xor_b32 v31, s97, v71
    v_xor_b32 v32, s97, v72
    v_xor_b32 v33, s97, v73
    v_xor_b32 v34, s97, v74
    v_xor_b32 v35, s97, v75
    v_xor_b32 v36, s97, v76
    v_xor_b32 v37, s97, v77
    v_xor_b32 v38, s97, v78
    v_xor_b32 v39, s97, v79
    v_or3_b32 v60, v24, v25, v26
    v_or3_b32 v60, v60, v27, v28
    v_or3_b32 v60, v60, v29, v30
    v_or3_b32 v60, v60, v31, v32
    v_or3_b32 v60, v60, v33, v34
    v_or3_b32 v60, v60, v35, v36
    v_or3_b32 v60, v60, v37, v38
    v_or_b32 v60, v60, v39
    v_and_b32 v60, 1023, v60
    v_cmp_ne_u32 s[8:9], 0, v60
    s_nop 0
    s_cmp_eq_u64 s[8:9], 0
    s_nop 1
    s_cbranch_scc1 L_g4d
    buffer_load_dwordx4 v[64:67], v21, s[52:55], s88 offen sc1
    buffer_load_dwordx4 v[68:71], v21, s[52:55], s89 offen sc1
    buffer_load_dwordx4 v[72:75], v21, s[52:55], s90 offen sc1
    buffer_load_dwordx4 v[76:79], v21, s[52:55], s91 offen sc1
    s_waitcnt vmcnt(4)
    v_xor_b32 v24, s97, v80
    v_xor_b32 v25, s97, v81
    v_xor_b32 v26, s97, v82
    v_xor_b32 v27, s97, v83
    v_xor_b32 v28, s97, v84
    v_xor_b32 v29, s97, v85
    v_xor_b32 v30, s97, v86
    v_xor_b32 v31, s97, v87
    v_xor_b32 v32, s97, v88
    v_xor_b32 v33, s97, v89
    v_xor_b32 v34, s97, v90
    v_xor_b32 v35, s97, v91
    v_xor_b32 v36, s97, v92
    v_xor_b32 v37, s97, v93
    v_xor_b32 v38, s97, v94
    v_xor_b32 v39, s97, v95
    v_or3_b32 v60, v24, v25, v26
    v_or3_b32 v60, v60, v27, v28
    v_or3_b32 v60, v60, v29, v30
    v_or3_b32 v60, v60, v31, v32
    v_or3_b32 v60, v60, v33, v34
    v_or3_b32 v60, v60, v35, v36
    v_or3_b32 v60, v60, v37, v38
    v_or_b32 v60, v60, v39
    v_and_b32 v60, 1023, v60
    v_cmp_ne_u32 s[8:9], 0, v60
    s_nop 0
    s_cmp_eq_u64 s[8:9], 0
    s_nop 1
    s_cbranch_scc1 L_g4d
    buffer_load_dwordx4 v[80:83], v21, s[52:55], s88 offen sc1
    buffer_load_dwordx4 v[84:87], v21, s[52:55], s89 offen sc1
    buffer_load_dwordx4 v[88:91], v21, s[52:55], s90 offen sc1
    buffer_load_dwordx4 v[92:95], v21, s[52:55], s91 offen sc1
    s_add_u32 s36, s36, 1
    s_and_b32 s62, s36, 255
    s_cbranch_scc1 L_rs15
    s_mov_b64 exec, -1
    buffer_wbl2 sc1
    s_waitcnt vmcnt(0)
    buffer_inv sc1
    s_waitcnt vmcnt(0)
L_rs15:
    s_cmp_lt_u32 s36, 65536
    s_cbranch_scc1 L_g4
L_g4d:
    v_pk_mul_f32 v[48:49], v[24:25], v[40:41] op_sel_hi:[1,0]
    v_pk_mul_f32 v[50:51], v[26:27], v[40:41] op_sel_hi:[1,0]
    v_pk_fma_f32 v[48:49], v[28:29], v[40:41], v[48:49] op_sel:[0,1,0] op_sel_hi:[1,1,1]
    v_pk_fma_f32 v[50:51], v[30:31], v[40:41], v[50:51] op_sel:[0,1,0] op_sel_hi:[1,1,1]
    v_pk_fma_f32 v[48:49], v[32:33], v[42:43], v[48:49] op_sel_hi:[1,0,1]
    v_pk_fma_f32 v[50:51], v[34:35], v[42:43], v[50:51] op_sel_hi:[1,0,1]
    v_pk_fma_f32 v[48:49], v[36:37], v[42:43], v[48:49] op_sel:[0,1,0] op_sel_hi:[1,1,1]
    v_pk_fma_f32 v[50:51], v[38:39], v[42:43], v[50:51] op_sel:[0,1,0] op_sel_hi:[1,1,1]
F_red32:
    s_nop 1
    v_permlane32_swap_b32 v48, v50
    v_permlane32_swap_b32 v49, v51
    v_pk_add_f32 v[48:49], v[48:49], v[50:51]
    v_mov_b32 v50, v48
    v_mov_b32 v51, v49
    s_nop 0
    v_permlane16_swap_b32 v48, v50
    v_permlane16_swap_b32 v49, v51
    v_pk_add_f32 v[48:49], v[48:49], v[50:51]
    s_nop 1
    v_add_f32_dpp v48, v48, v48 row_ror:8 row_mask:0xf bank_mask:0xf
    v_add_f32_dpp v49, v49, v49 row_ror:8 row_mask:0xf bank_mask:0xf
    v_cvt_pk_bf16_f32 v50, v48, v49
    s_cmp_eq_u32 s34, 0
    s_cbranch_scc1 L_r32r
    v_lshl_or_b32 v48, v50, 16, v15
    v_and_or_b32 v49, v50, s15, v15
    v_mov_b32 v50, v48
    v_mov_b32 v51, v49
    s_nop 0
    v_permlane32_swap_b32 v48, v50
    v_permlane32_swap_b32 v49, v51
    s_mov_b64 exec, 0xff
    s_cmp_eq_u32 s34, 2
    s_cbranch_scc1 L_r32l
    buffer_store_dwordx4 v[48:51], v7, s[52:55], s23 offen sc1
    s_add_u32 s23, s23, 32768
L_r32l:
    buffer_store_dwordx4 v[48:51], v7, s[52:55], s23 offen
    s_mov_b64 exec, -1
L_r32r:
    s_setpc_b64 s[60:61]
F_fst:
    s_mov_b32 s63, 0
L_sp16:
    ds_read_b32 v5, v4 offset:68
    s_add_u32 s63, s63, 1
    s_waitcnt lgkmcnt(0)
    v_readfirstlane_b32 s62, v5
    s_nop 0
    s_cmp_ge_u32 s62, s38
    s_nop 1
    s_cbranch_scc1 L_sd17
    s_cmp_lt_u32 s63, 0x200000
    s_cbranch_scc1 L_sp16
L_sd17:
    s_mov_b64 exec, s[28:29]
    ds_read_b64 v[56:57], v60
    v_mov_b32 v58, s33
    s_waitcnt lgkmcnt(0)
    v_xor_b32 v56, s97, v56
    v_xor_b32 v57, s97, v57
    s_mov_b64 exec, -1
    v_cmp_ne_u32 s[8:9], s33, v58
    v_mov_b32 v58, v56
    s_nop 1
    v_max_f32_dpp v58, v58, v58 row_ror:8 row_mask:0xf bank_mask:0xf
    s_nop 1
    v_max_f32_dpp v58, v58, v58 row_ror:4 row_mask:0xf bank_mask:0xf
    s_nop 1
    v_max_f32_dpp v58, v58, v58 row_ror:2 row_mask:0xf bank_mask:0xf
    s_nop 1
    v_max_f32_dpp v58, v58, v58 row_ror:1 row_mask:0xf bank_mask:0xf
    v_mov_b32 v59, v58
    s_nop 1
    v_permlane16_swap_b32 v59, v58
    v_max_f32 v58, v58, v59
    v_sub_f32 v56, v56, v58
    v_mul_f32 v56, s31, v56
    v_exp_f32 v56, v56
    s_nop 0
    v_mul_f32 v57, v56, v57
    s_nop 1
    v_add_f32_dpp v57, v57, v57 row_ror:8 row_mask:0xf bank_mask:0xf
    s_nop 1
    v_add_f32_dpp v57, v57, v57 row_ror:4 row_mask:0xf bank_mask:0xf
    s_nop 1
    v_add_f32_dpp v57, v57, v57 row_ror:2 row_mask:0xf bank_mask:0xf
    s_nop 1
    v_add_f32_dpp v57, v57, v57 row_ror:1 row_mask:0xf bank_mask:0xf
    v_mov_b32 v59, v57
    s_nop 1
    v_permlane16_swap_b32 v59, v57
    v_add_f32 v57, v57, v59
    v_rcp_f32 v57, v57
    s_nop 0
    v_mul_f32 v56, v56, v57
    ds_write_b32 v63, v56
    v_mov_b32 v5, s38
    ds_max_u32 v4, v5 offset:88
    s_setpc_b64 s[60:61]
F_gfin:
    v_lshlrev_b32 v48, 16, v50
    v_and_b32 v49, s15, v50
    v_lshlrev_b32 v46, 16, v44
    v_and_b32 v47, s15, v44
    v_pk_add_f32 v[48:49], v[48:49], v[46:47]
    v_cvt_pk_bf16_f32 v50, v48, v49
    v_lshlrev_b32 v48, 16, v50
    v_and_b32 v49, s15, v50
    v_mul_f32 v46, 0xbfb8aa3b, v48
    v_mul_f32 v47, 0xbfb8aa3b, v49
    v_exp_f32 v46, v46
    v_exp_f32 v47, v47
    v_add_f32 v46, 1.0, v46
    v_add_f32 v47, 1.0, v47
    v_rcp_f32 v46, v46
    v_rcp_f32 v47, v47
    s_nop 0
    v_pk_mul_f32 v[48:49], v[48:49], v[46:47]
    v_cvt_pk_bf16_f32 v50, v48, v49
    v_lshlrev_b32 v48, 16, v50
    v_and_b32 v49, s15, v50
    ds_write_b64 v23, v[48:49]
    ds_max_u32 v4, v18 offset:56
    s_setpc_b64 s[60:61]
F_fin:
    s_mov_b32 s36, s37
    buffer_load_dwordx4 v[64:67], v21, s[52:55], s88 offen sc1
    buffer_load_dwordx4 v[68:71], v21, s[52:55], s89 offen sc1
    buffer_load_dwordx4 v[72:75], v21, s[52:55], s90 offen sc1
    buffer_load_dwordx4 v[76:79], v21, s[52:55], s91 offen sc1
    s_sleep 2
    buffer_load_dwordx4 v[80:83], v21, s[52:55], s88 offen sc1
    buffer_load_dwordx4 v[84:87], v21, s[52:55], s89 offen sc1
    buffer_load_dwordx4 v[88:91], v21, s[52:55], s90 offen sc1
    buffer_load_dwordx4 v[92:95], v21, s[52:55], s91 offen sc1
L_fn:
    s_waitcnt vmcnt(4)
    v_xor_b32 v24, s97, v64
    v_xor_b32 v25, s97, v65
    v_xor_b32 v26, s97, v66
    v_xor_b32 v27, s97, v67
    v_xor_b32 v28, s97, v68
    v_xor_b32 v29, s97, v69
    v_xor_b32 v30, s97, v70
    v_xor_b32 v31, s97, v71
    v_xor_b32 v32, s97, v72
    v_xor_b32 v33, s97, v73
    v_xor_b32 v34, s97, v74
    v_xor_b32 v35, s97, v75
    v_xor_b32 v36, s97, v76
    v_xor_b32 v37, s97, v77
    v_xor_b32 v38, s97, v78
    v_xor_b32 v39, s97, v79
    v_or3_b32 v60, v24, v25, v26
    v_or3_b32 v60, v60, v27, v28
    v_or3_b32 v60, v60, v29, v30
    v_or3_b32 v60, v60, v31, v32
    v_or3_b32 v60, v60, v33, v34
    v_or3_b32 v60, v60, v35, v36
    v_or3_b32 v60, v60, v37, v38
    v_or_b32 v60, v60, v39
    v_and_b32 v60, 1023, v60
    v_cmp_ne_u32 s[8:9], 0, v60
    s_nop 0
    s_cmp_eq_u64 s[8:9], 0
    s_nop 1
    s_cbranch_scc1 L_fnd
    buffer_load_dwordx4 v[64:67], v21, s[52:55], s88 offen sc1
    buffer_load_dwordx4 v[68:71], v21, s[52:55], s89 offen sc1
    buffer_load_dwordx4 v[72:75], v21, s[52:55], s90 offen sc1
    buffer_load_dwordx4 v[76:79], v21, s[52:55], s91 offen sc1
    s_waitcnt vmcnt(4)
    v_xor_b32 v24, s97, v80
    v_xor_b32 v25, s97, v81
    v_xor_b32 v26, s97, v82
    v_xor_b32 v27, s97, v83
    v_xor_b32 v28, s97, v84
    v_xor_b32 v29, s97, v85
    v_xor_b32 v30, s97, v86
    v_xor_b32 v31, s97, v87
    v_xor_b32 v32, s97, v88
    v_xor_b32 v33, s97, v89
    v_xor_b32 v34, s97, v90
    v_xor_b32 v35, s97, v91
    v_xor_b32 v36, s97, v92
    v_xor_b32 v37, s97, v93
    v_xor_b32 v38, s97, v94
    v_xor_b32 v39, s97, v95
    v_or3_b32 v60, v24, v25, v26
    v_or3_b32 v60, v60, v27, v28
    v_or3_b32 v60, v60, v29, v30
    v_or3_b32 v60, v60, v31, v32
    v_or3_b32 v60, v60, v33, v34
    v_or3_b32 v60, v60, v35, v36
    v_or3_b32 v60, v60, v37, v38
    v_or_b32 v60, v60, v39
    v_and_b32 v60, 1023, v60
    v_cmp_ne_u32 s[8:9], 0, v60
    s_nop 0
    s_cmp_eq_u64 s[8:9], 0
    s_nop 1
    s_cbranch_scc1 L_fnd
    buffer_load_dwordx4 v[80:83], v21, s[52:55], s88 offen sc1
    buffer_load_dwordx4 v[84:87], v21, s[52:55], s89 offen sc1
    buffer_load_dwordx4 v[88:91], v21, s[52:55], s90 offen sc1
    buffer_load_dwordx4 v[92:95], v21, s[52:55], s91 offen sc1
    s_add_u32 s36, s36, 1
    s_and_b32 s62, s36, 255
    s_cbranch_scc1 L_rs18
    s_mov_b64 exec, -1
    buffer_wbl2 sc1
    s_waitcnt vmcnt(0)
    buffer_inv sc1
    s_waitcnt vmcnt(0)
L_rs18:
    s_cmp_lt_u32 s36, 65536
    s_cbranch_scc1 L_fn
L_fnd:
F_sfin:
    s_mov_b32 s63, 0
    ds_read_b32 v5, v4 offset:56
    ds_read_b64 v[46:47], v23
    v_pk_add_f32 v[24:25], v[24:25], v[28:29]
    v_pk_add_f32 v[26:27], v[26:27], v[30:31]
    v_pk_add_f32 v[32:33], v[32:33], v[36:37]
    v_pk_add_f32 v[34:35], v[34:35], v[38:39]
    v_pk_add_f32 v[48:49], v[24:25], v[32:33]
    v_pk_add_f32 v[50:51], v[26:27], v[34:35]
    v_lshlrev_b32 v52, 16, v44
    v_and_b32 v53, s15, v44
    v_permlane32_swap_b32 v48, v50
    v_permlane32_swap_b32 v49, v51
    v_pk_add_f32 v[48:49], v[48:49], v[50:51]
    v_mov_b32 v50, v48
    v_mov_b32 v51, v49
    s_mov_b32 s8, 0xff
    s_mov_b32 s9, 0xff
    v_permlane16_swap_b32 v48, v50
    v_permlane16_swap_b32 v49, v51
    v_pk_add_f32 v[48:49], v[48:49], v[50:51]
    s_waitcnt lgkmcnt(0)
    v_readfirstlane_b32 s62, v5
    v_add_f32_dpp v48, v48, v48 row_ror:8 row_mask:0xf bank_mask:0xf
    v_add_f32_dpp v49, v49, v49 row_ror:8 row_mask:0xf bank_mask:0xf
    v_cvt_pk_bf16_f32 v50, v48, v49
    v_lshlrev_b32 v48, 16, v50
    v_and_b32 v49, s15, v50
    s_cmp_ge_u32 s62, s38
    s_cbranch_scc1 L_gok
L_gw:
    ds_read_b32 v5, v4 offset:56
    ds_read_b64 v[46:47], v23
    s_add_u32 s63, s63, 1
    s_waitcnt lgkmcnt(0)
    v_readfirstlane_b32 s62, v5
    s_nop 0
    s_cmp_ge_u32 s62, s38
    s_nop 1
    s_cbranch_scc1 L_gok
    s_cmp_lt_u32 s63, 0x200000
    s_cbranch_scc1 L_gw
L_gok:
    v_pk_mul_f32 v[48:49], v[48:49], v[46:47]
    v_cvt_pk_bf16_f32 v50, v48, v49
    v_lshlrev_b32 v48, 16, v50
    v_and_b32 v49, s15, v50
    v_pk_add_f32 v[48:49], v[48:49], v[52:53]
    s_mov_b64 exec, s[8:9]
    v_cvt_pk_bf16_f32 v48, v48, v49
    buffer_store_dword v48, v20, s[56:59], s23 offen
    s_mov_b64 exec, -1
    s_setpc_b64 s[60:61]
F_p2:
    s_mov_b32 s36, s37
    buffer_load_dwordx4 v[96:99], v62, s[52:55], s88 offen sc1
    buffer_load_dwordx4 v[100:103], v63, s[52:55], s89 offen sc1
    s_sleep 3
    s_cmp_eq_u32 s35, 0
    s_cbranch_scc1 L_ps19
    s_sleep 3
L_ps19:
    buffer_load_dwordx4 v[104:107], v62, s[52:55], s88 offen sc1
    buffer_load_dwordx4 v[108:111], v63, s[52:55], s89 offen sc1
L_p2:
    s_waitcnt vmcnt(2)
    v_xor_b32 v48, s97, v96
    v_xor_b32 v49, s97, v97
    v_xor_b32 v50, s97, v98
    v_xor_b32 v51, s97, v99
    v_xor_b32 v52, s97, v100
    v_xor_b32 v53, s97, v101
    v_xor_b32 v54, s97, v102
    v_xor_b32 v55, s97, v103
    v_or3_b32 v56, v48, v49, v50
    v_or3_b32 v56, v56, v51, v52
    v_or3_b32 v56, v56, v53, v54
    v_or_b32 v56, v56, v55
    v_and_b32 v56, 1023, v56
    v_cmp_ne_u32 s[8:9], 0, v56
    s_nop 0
    s_cmp_eq_u64 s[8:9], 0
    s_nop 1
    s_cbranch_scc1 L_p2d
    buffer_load_dwordx4 v[96:99], v62, s[52:55], s88 offen sc1
    buffer_load_dwordx4 v[100:103], v63, s[52:55], s89 offen sc1
    s_waitcnt vmcnt(2)
    v_xor_b32 v48, s97, v104
    v_xor_b32 v49, s97, v105
    v_xor_b32 v50, s97, v106
    v_xor_b32 v51, s97, v107
    v_xor_b32 v52, s97, v108
    v_xor_b32 v53, s97, v109
    v_xor_b32 v54, s97, v110
    v_xor_b32 v55, s97, v111
    v_or3_b32 v56, v48, v49, v50
    v_or3_b32 v56, v56, v51, v52
    v_or3_b32 v56, v56, v53, v54
    v_or_b32 v56, v56, v55
    v_and_b32 v56, 1023, v56
    v_cmp_ne_u32 s[8:9], 0, v56
    s_nop 0
    s_cmp_eq_u64 s[8:9], 0
    s_nop 1
    s_cbranch_scc1 L_p2d
    buffer_load_dwordx4 v[104:107], v62, s[52:55], s88 offen sc1
    buffer_load_dwordx4 v[108:111], v63, s[52:55], s89 offen sc1
    s_add_u32 s36, s36, 1
    s_and_b32 s62, s36, 255
    s_cbranch_scc1 L_rs20
    s_mov_b64 exec, -1
    buffer_wbl2 sc1
    s_waitcnt vmcnt(0)
    buffer_inv sc1
    s_waitcnt vmcnt(0)
L_rs20:
    s_cmp_lt_u32 s36, 65536
    s_cbranch_scc1 L_p2
L_p2d:
    s_setpc_b64 s[60:61]
L_mlp:
    s_cmp_lg_u32 s11, 3
    s_cbranch_scc1 L_hnf
    v_mov_b32 v5, 1
    ds_write_b32 v4, v5 offset:20
L_hnf:
    s_lshl_b32 s10, s14, 8
    s_lshl_b32 s11, s6, 6
    s_add_u32 s10, s10, s11
    s_add_u32 s100, s30, s10
    s_addc_u32 s101, s31, 0
    global_load_dword v58, v61, s[100:101]
    s_lshl_b32 s10, s14, 13
    s_lshl_b32 s11, s6, 7
    s_add_u32 s10, s10, s11
    s_add_u32 s88, s10, 589824
    s_add_u32 s89, s88, 512
    v_mov_b32 v63, v62
    v_lshlrev_b32 v6, 14, v2
    v_lshl_add_u32 v6, v3, 4, v6
    s_lshl_b32 s94, s14, 18
    s_lshl_b32 s11, s6, 16
    s_add_u32 s94, s94, s11
    s_lshl_b32 s11, s13, 8
    s_add_u32 s94, s94, s11
    s_mov_b32 s63, 0
L_sp21:
    ds_read_b32 v5, v4 offset:20
    s_add_u32 s63, s63, 1
    s_waitcnt lgkmcnt(0)
    v_readfirstlane_b32 s62, v5
    s_nop 0
    s_cmp_ge_u32 s62, 1
    s_nop 1
    s_cbranch_scc1 L_sd22
    s_sleep 2
    s_cmp_lt_u32 s63, 0x200000
    s_cbranch_scc1 L_sp21
L_sd22:
    s_mov_b32 s63, 0
L_sp23:
    ds_read_b32 v5, v4 offset:64
    s_add_u32 s63, s63, 1
    s_waitcnt lgkmcnt(0)
    v_readfirstlane_b32 s62, v5
    s_nop 0
    s_cmp_ge_u32 s62, 4
    s_nop 1
    s_cbranch_scc1 L_sd24
    s_sleep 2
    s_cmp_lt_u32 s63, 0x200000
    s_cbranch_scc1 L_sp23
L_sd24:
    s_mov_b32 s37, 0
    s_mov_b32 s35, 1
    s_call_b64 s[60:61], F_p2
    s_call_b64 s[60:61], F_act
    s_mov_b32 s63, 0
L_sp25:
    ds_read_b32 v5, v4 offset:68
    s_add_u32 s63, s63, 1
    s_waitcnt lgkmcnt(0)
    v_readfirstlane_b32 s62, v5
    s_nop 0
    s_cmp_ge_u32 s62, 1
    s_nop 1
    s_cbranch_scc1 L_sd26
    s_sleep 1
    s_cmp_lt_u32 s63, 0x200000
    s_cbranch_scc1 L_sp25
L_sd26:
    buffer_load_dwordx4 v[64:67], v6, s[48:51], s94 offen offset:0 nt
    buffer_load_dwordx4 v[68:71], v6, s[48:51], s94 offen offset:2048 nt
    s_add_u32 s94, s94, 4096
    buffer_load_dwordx4 v[72:75], v6, s[48:51], s94 offen offset:0 nt
    buffer_load_dwordx4 v[76:79], v6, s[48:51], s94 offen offset:2048 nt
    s_add_u32 s94, s94, 4096
    buffer_load_dwordx4 v[80:83], v6, s[48:51], s94 offen offset:0 nt
    buffer_load_dwordx4 v[84:87], v6, s[48:51], s94 offen offset:2048 nt
    s_add_u32 s94, s94, 4096
    buffer_load_dwordx4 v[88:91], v6, s[48:51], s94 offen offset:0 nt
    buffer_load_dwordx4 v[92:95], v6, s[48:51], s94 offen offset:2048 nt
    s_setprio 1
    s_mov_b32 s10, s42
    s_waitcnt vmcnt(0)
L_w2g:
    s_cmp_lg_u32 s13, s4
    s_cselect_b32 s38, 1, 0
    s_call_b64 s[60:61], F_gemv
    v_mov_b32 v5, 1
    s_mov_b64 exec, 1
    ds_add_u32 v4, v5 offset:72
    s_mov_b64 exec, -1
    s_branch L_fin
F_act:
    v_permlane32_swap_b32 v48, v52
    v_permlane32_swap_b32 v49, v53
    v_permlane32_swap_b32 v50, v54
    v_permlane32_swap_b32 v51, v55
    v_pk_add_f32 v[48:49], v[48:49], v[52:53]
    v_pk_add_f32 v[50:51], v[50:51], v[54:55]
    s_nop 1
    v_permlane16_swap_b32 v48, v50
    v_permlane16_swap_b32 v49, v51
    v_pk_add_f32 v[48:49], v[48:49], v[50:51]
    v_lshlrev_b32 v56, 16, v58
    v_and_b32 v57, s15, v58
    v_add_f32_dpp v48, v48, v48 row_ror:8 row_mask:0xf bank_mask:0xf
    v_add_f32_dpp v49, v49, v49 row_ror:8 row_mask:0xf bank_mask:0xf
    v_cvt_pk_bf16_f32 v50, v48, v49
    v_lshlrev_b32 v48, 16, v50
    v_and_b32 v49, s15, v50
    v_pk_add_f32 v[48:49], v[48:49], v[56:57]
    v_cvt_pk_bf16_f32 v50, v48, v49
    v_lshlrev_b32 v48, 16, v50
    v_and_b32 v49, s15, v50
    v_pk_mul_f32 v[56:57], v[48:49], v[48:49]
    v_mul_f32 v56, 0x3d372713, v56
    v_mul_f32 v57, 0x3d372713, v57
    v_pk_fma_f32 v[56:57], v[56:57], v[48:49], v[48:49]
    v_mul_f32 v56, 0xc0135761, v56
    v_mul_f32 v57, 0xc0135761, v57
    v_exp_f32 v56, v56
    v_exp_f32 v57, v57
    v_add_f32 v56, 1.0, v56
    v_add_f32 v57, 1.0, v57
    v_rcp_f32 v56, v56
    v_rcp_f32 v57, v57
    s_nop 0
    v_pk_mul_f32 v[48:49], v[48:49], v[56:57]
    v_cvt_pk_bf16_f32 v50, v48, v49
    ds_write_b32 v13, v50
    ds_read_b128 v[24:27], v14
    s_setpc_b64 s[60:61]
L_nomlp:
    v_mov_b32 v5, 1
    ds_write_b32 v4, v5 offset:20
    v_mov_b32 v5, 1
    s_mov_b64 exec, 1
    ds_add_u32 v4, v5 offset:72
    s_mov_b64 exec, -1
    s_branch L_fin
F_ln:
    v_lshlrev_b32 v96, 16, v40
    v_and_b32 v97, s15, v40
    v_lshlrev_b32 v98, 16, v41
    v_and_b32 v99, s15, v41
    v_lshlrev_b32 v100, 16, v42
    v_and_b32 v101, s15, v42
    v_lshlrev_b32 v102, 16, v43
    v_and_b32 v103, s15, v43
    v_lshlrev_b32 v104, 16, v44
    v_and_b32 v105, s15, v44
    v_lshlrev_b32 v106, 16, v45
    v_and_b32 v107, s15, v45
    v_lshlrev_b32 v108, 16, v46
    v_and_b32 v109, s15, v46
    v_lshlrev_b32 v110, 16, v47
    v_and_b32 v111, s15, v47
    v_lshlrev_b32 v112, 16, v48
    v_and_b32 v113, s15, v48
    v_lshlrev_b32 v114, 16, v49
    v_and_b32 v115, s15, v49
    v_lshlrev_b32 v116, 16, v50
    v_and_b32 v117, s15, v50
    v_lshlrev_b32 v118, 16, v51
    v_and_b32 v119, s15, v51
    v_lshlrev_b32 v120, 16, v52
    v_and_b32 v121, s15, v52
    v_lshlrev_b32 v122, 16, v53
    v_and_b32 v123, s15, v53
    v_lshlrev_b32 v124, 16, v54
    v_and_b32 v125, s15, v54
    v_lshlrev_b32 v126, 16, v55
    v_and_b32 v127, s15, v55
    v_pk_add_f32 v[56:57], v[96:97], v[98:99]
    v_pk_add_f32 v[58:59], v[100:101], v[102:103]
    v_pk_add_f32 v[56:57], v[56:57], v[104:105]
    v_pk_add_f32 v[58:59], v[58:59], v[106:107]
    v_pk_add_f32 v[56:57], v[56:57], v[108:109]
    v_pk_add_f32 v[58:59], v[58:59], v[110:111]
    v_pk_add_f32 v[56:57], v[56:57], v[112:113]
    v_pk_add_f32 v[58:59], v[58:59], v[114:115]
    v_pk_add_f32 v[56:57], v[56:57], v[116:117]
    v_pk_add_f32 v[58:59], v[58:59], v[118:119]
    v_pk_add_f32 v[56:57], v[56:57], v[120:121]
    v_pk_add_f32 v[58:59], v[58:59], v[122:123]
    v_pk_add_f32 v[56:57], v[56:57], v[124:125]
    v_pk_add_f32 v[58:59], v[58:59], v[126:127]
    v_pk_add_f32 v[56:57], v[56:57], v[58:59]
    v_add_f32 v56, v56, v57
    s_nop 1
    v_add_f32_dpp v56, v56, v56 row_ror:8 row_mask:0xf bank_mask:0xf
    s_nop 1
    v_add_f32_dpp v56, v56, v56 row_ror:4 row_mask:0xf bank_mask:0xf
    s_nop 1
    v_add_f32_dpp v56, v56, v56 row_ror:2 row_mask:0xf bank_mask:0xf
    s_nop 1
    v_add_f32_dpp v56, v56, v56 row_ror:1 row_mask:0xf bank_mask:0xf
    v_mov_b32 v57, v56
    s_nop 1
    v_permlane16_swap_b32 v57, v56
    v_add_f32 v56, v56, v57
    v_mul_f32 v56, 0x3a800000, v56
    v_pk_add_f32 v[58:59], v[96:97], v[56:57] op_sel_hi:[1,0] neg_lo:[0,1] neg_hi:[0,1]
    v_pk_mul_f32 v[62:63], v[58:59], v[58:59]
    v_pk_add_f32 v[60:61], v[98:99], v[56:57] op_sel_hi:[1,0] neg_lo:[0,1] neg_hi:[0,1]
    v_pk_fma_f32 v[62:63], v[60:61], v[60:61], v[62:63]
    v_pk_add_f32 v[58:59], v[100:101], v[56:57] op_sel_hi:[1,0] neg_lo:[0,1] neg_hi:[0,1]
    v_pk_fma_f32 v[62:63], v[58:59], v[58:59], v[62:63]
    v_pk_add_f32 v[60:61], v[102:103], v[56:57] op_sel_hi:[1,0] neg_lo:[0,1] neg_hi:[0,1]
    v_pk_fma_f32 v[62:63], v[60:61], v[60:61], v[62:63]
    v_pk_add_f32 v[58:59], v[104:105], v[56:57] op_sel_hi:[1,0] neg_lo:[0,1] neg_hi:[0,1]
    v_pk_fma_f32 v[62:63], v[58:59], v[58:59], v[62:63]
    v_pk_add_f32 v[60:61], v[106:107], v[56:57] op_sel_hi:[1,0] neg_lo:[0,1] neg_hi:[0,1]
    v_pk_fma_f32 v[62:63], v[60:61], v[60:61], v[62:63]
    v_pk_add_f32 v[58:59], v[108:109], v[56:57] op_sel_hi:[1,0] neg_lo:[0,1] neg_hi:[0,1]
    v_pk_fma_f32 v[62:63], v[58:59], v[58:59], v[62:63]
    v_pk_add_f32 v[60:61], v[110:111], v[56:57] op_sel_hi:[1,0] neg_lo:[0,1] neg_hi:[0,1]
    v_pk_fma_f32 v[62:63], v[60:61], v[60:61], v[62:63]
    v_pk_add_f32 v[58:59], v[112:113], v[56:57] op_sel_hi:[1,0] neg_lo:[0,1] neg_hi:[0,1]
    v_pk_fma_f32 v[62:63], v[58:59], v[58:59], v[62:63]
    v_pk_add_f32 v[60:61], v[114:115], v[56:57] op_sel_hi:[1,0] neg_lo:[0,1] neg_hi:[0,1]
    v_pk_fma_f32 v[62:63], v[60:61], v[60:61], v[62:63]
    v_pk_add_f32 v[58:59], v[116:117], v[56:57] op_sel_hi:[1,0] neg_lo:[0,1] neg_hi:[0,1]
    v_pk_fma_f32 v[62:63], v[58:59], v[58:59], v[62:63]
    v_pk_add_f32 v[60:61], v[118:119], v[56:57] op_sel_hi:[1,0] neg_lo:[0,1] neg_hi:[0,1]
    v_pk_fma_f32 v[62:63], v[60:61], v[60:61], v[62:63]
    v_pk_add_f32 v[58:59], v[120:121], v[56:57] op_sel_hi:[1,0] neg_lo:[0,1] neg_hi:[0,1]
    v_pk_fma_f32 v[62:63], v[58:59], v[58:59], v[62:63]
    v_pk_add_f32 v[60:61], v[122:123], v[56:57] op_sel_hi:[1,0] neg_lo:[0,1] neg_hi:[0,1]
    v_pk_fma_f32 v[62:63], v[60:61], v[60:61], v[62:63]
    v_pk_add_f32 v[58:59], v[124:125], v[56:57] op_sel_hi:[1,0] neg_lo:[0,1] neg_hi:[0,1]
    v_pk_fma_f32 v[62:63], v[58:59], v[58:59], v[62:63]
    v_pk_add_f32 v[60:61], v[126:127], v[56:57] op_sel_hi:[1,0] neg_lo:[0,1] neg_hi:[0,1]
    v_pk_fma_f32 v[62:63], v[60:61], v[60:61], v[62:63]
    v_add_f32 v62, v62, v63
    s_nop 1
    v_add_f32_dpp v62, v62, v62 row_ror:8 row_mask:0xf bank_mask:0xf
    s_nop 1
    v_add_f32_dpp v62, v62, v62 row_ror:4 row_mask:0xf bank_mask:0xf
    s_nop 1
    v_add_f32_dpp v62, v62, v62 row_ror:2 row_mask:0xf bank_mask:0xf
    s_nop 1
    v_add_f32_dpp v62, v62, v62 row_ror:1 row_mask:0xf bank_mask:0xf
    v_mov_b32 v63, v62
    s_nop 1
    v_permlane16_swap_b32 v63, v62
    v_add_f32 v62, v62, v63
    v_mul_f32 v62, 0x3a800000, v62
    v_cvt_pk_bf16_f32 v58, v56, v62
    v_lshlrev_b32 v56, 16, v58
    v_and_b32 v62, s15, v58
    v_add_f32 v62, 0x3727c5ac, v62
    v_cvt_pk_bf16_f32 v58, v62, v62
    v_lshlrev_b32 v62, 16, v58
    v_sqrt_f32 v62, v62
    s_nop 0
    v_cvt_pk_bf16_f32 v58, v62, v62
    v_lshlrev_b32 v62, 16, v58
    v_rcp_f32 v62, v62
    v_pk_add_f32 v[96:97], v[96:97], v[56:57] op_sel_hi:[1,0] neg_lo:[0,1] neg_hi:[0,1]
    v_pk_add_f32 v[98:99], v[98:99], v[56:57] op_sel_hi:[1,0] neg_lo:[0,1] neg_hi:[0,1]
    v_pk_add_f32 v[100:101], v[100:101], v[56:57] op_sel_hi:[1,0] neg_lo:[0,1] neg_hi:[0,1]
    v_pk_add_f32 v[102:103], v[102:103], v[56:57] op_sel_hi:[1,0] neg_lo:[0,1] neg_hi:[0,1]
    v_pk_add_f32 v[104:105], v[104:105], v[56:57] op_sel_hi:[1,0] neg_lo:[0,1] neg_hi:[0,1]
    v_pk_add_f32 v[106:107], v[106:107], v[56:57] op_sel_hi:[1,0] neg_lo:[0,1] neg_hi:[0,1]
    v_pk_add_f32 v[108:109], v[108:109], v[56:57] op_sel_hi:[1,0] neg_lo:[0,1] neg_hi:[0,1]
    v_pk_add_f32 v[110:111], v[110:111], v[56:57] op_sel_hi:[1,0] neg_lo:[0,1] neg_hi:[0,1]
    v_pk_add_f32 v[112:113], v[112:113], v[56:57] op_sel_hi:[1,0] neg_lo:[0,1] neg_hi:[0,1]
    v_pk_add_f32 v[114:115], v[114:115], v[56:57] op_sel_hi:[1,0] neg_lo:[0,1] neg_hi:[0,1]
    v_pk_add_f32 v[116:117], v[116:117], v[56:57] op_sel_hi:[1,0] neg_lo:[0,1] neg_hi:[0,1]
    v_pk_add_f32 v[118:119], v[118:119], v[56:57] op_sel_hi:[1,0] neg_lo:[0,1] neg_hi:[0,1]
    v_pk_add_f32 v[120:121], v[120:121], v[56:57] op_sel_hi:[1,0] neg_lo:[0,1] neg_hi:[0,1]
    v_pk_add_f32 v[122:123], v[122:123], v[56:57] op_sel_hi:[1,0] neg_lo:[0,1] neg_hi:[0,1]
    v_pk_add_f32 v[124:125], v[124:125], v[56:57] op_sel_hi:[1,0] neg_lo:[0,1] neg_hi:[0,1]
    v_pk_add_f32 v[126:127], v[126:127], v[56:57] op_sel_hi:[1,0] neg_lo:[0,1] neg_hi:[0,1]
    v_cvt_pk_bf16_f32 v40, v96, v97
    v_cvt_pk_bf16_f32 v41, v98, v99
    v_cvt_pk_bf16_f32 v42, v100, v101
    v_cvt_pk_bf16_f32 v43, v102, v103
    v_cvt_pk_bf16_f32 v44, v104, v105
    v_cvt_pk_bf16_f32 v45, v106, v107
    v_cvt_pk_bf16_f32 v46, v108, v109
    v_cvt_pk_bf16_f32 v47, v110, v111
    v_cvt_pk_bf16_f32 v48, v112, v113
    v_cvt_pk_bf16_f32 v49, v114, v115
    v_cvt_pk_bf16_f32 v50, v116, v117
    v_cvt_pk_bf16_f32 v51, v118, v119
    v_cvt_pk_bf16_f32 v52, v120, v121
    v_cvt_pk_bf16_f32 v53, v122, v123
    v_cvt_pk_bf16_f32 v54, v124, v125
    v_cvt_pk_bf16_f32 v55, v126, v127
    v_lshlrev_b32 v96, 16, v40
    v_and_b32 v97, s15, v40
    v_lshlrev_b32 v98, 16, v41
    v_and_b32 v99, s15, v41
    v_lshlrev_b32 v100, 16, v42
    v_and_b32 v101, s15, v42
    v_lshlrev_b32 v102, 16, v43
    v_and_b32 v103, s15, v43
    v_lshlrev_b32 v104, 16, v44
    v_and_b32 v105, s15, v44
    v_lshlrev_b32 v106, 16, v45
    v_and_b32 v107, s15, v45
    v_lshlrev_b32 v108, 16, v46
    v_and_b32 v109, s15, v46
    v_lshlrev_b32 v110, 16, v47
    v_and_b32 v111, s15, v47
    v_lshlrev_b32 v112, 16, v48
    v_and_b32 v113, s15, v48
    v_lshlrev_b32 v114, 16, v49
    v_and_b32 v115, s15, v49
    v_lshlrev_b32 v116, 16, v50
    v_and_b32 v117, s15, v50
    v_lshlrev_b32 v118, 16, v51
    v_and_b32 v119, s15, v51
    v_lshlrev_b32 v120, 16, v52
    v_and_b32 v121, s15, v52
    v_lshlrev_b32 v122, 16, v53
    v_and_b32 v123, s15, v53
    v_lshlrev_b32 v124, 16, v54
    v_and_b32 v125, s15, v54
    v_lshlrev_b32 v126, 16, v55
    v_and_b32 v127, s15, v55
    v_pk_mul_f32 v[96:97], v[96:97], v[62:63] op_sel_hi:[1,0]
    v_pk_mul_f32 v[98:99], v[98:99], v[62:63] op_sel_hi:[1,0]
    v_pk_mul_f32 v[100:101], v[100:101], v[62:63] op_sel_hi:[1,0]
    v_pk_mul_f32 v[102:103], v[102:103], v[62:63] op_sel_hi:[1,0]
    v_pk_mul_f32 v[104:105], v[104:105], v[62:63] op_sel_hi:[1,0]
    v_pk_mul_f32 v[106:107], v[106:107], v[62:63] op_sel_hi:[1,0]
    v_pk_mul_f32 v[108:109], v[108:109], v[62:63] op_sel_hi:[1,0]
    v_pk_mul_f32 v[110:111], v[110:111], v[62:63] op_sel_hi:[1,0]
    v_pk_mul_f32 v[112:113], v[112:113], v[62:63] op_sel_hi:[1,0]
    v_pk_mul_f32 v[114:115], v[114:115], v[62:63] op_sel_hi:[1,0]
    v_pk_mul_f32 v[116:117], v[116:117], v[62:63] op_sel_hi:[1,0]
    v_pk_mul_f32 v[118:119], v[118:119], v[62:63] op_sel_hi:[1,0]
    v_pk_mul_f32 v[120:121], v[120:121], v[62:63] op_sel_hi:[1,0]
    v_pk_mul_f32 v[122:123], v[122:123], v[62:63] op_sel_hi:[1,0]
    v_pk_mul_f32 v[124:125], v[124:125], v[62:63] op_sel_hi:[1,0]
    v_pk_mul_f32 v[126:127], v[126:127], v[62:63] op_sel_hi:[1,0]
    v_cvt_pk_bf16_f32 v40, v96, v97
    v_cvt_pk_bf16_f32 v41, v98, v99
    v_cvt_pk_bf16_f32 v42, v100, v101
    v_cvt_pk_bf16_f32 v43, v102, v103
    v_cvt_pk_bf16_f32 v44, v104, v105
    v_cvt_pk_bf16_f32 v45, v106, v107
    v_cvt_pk_bf16_f32 v46, v108, v109
    v_cvt_pk_bf16_f32 v47, v110, v111
    v_cvt_pk_bf16_f32 v48, v112, v113
    v_cvt_pk_bf16_f32 v49, v114, v115
    v_cvt_pk_bf16_f32 v50, v116, v117
    v_cvt_pk_bf16_f32 v51, v118, v119
    v_cvt_pk_bf16_f32 v52, v120, v121
    v_cvt_pk_bf16_f32 v53, v122, v123
    v_cvt_pk_bf16_f32 v54, v124, v125
    v_cvt_pk_bf16_f32 v55, v126, v127
    s_nop 0
    s_setpc_b64 s[60:61]
F_hop2:
    s_mov_b32 s36, s37
    buffer_load_dwordx4 v[96:99], v62, s[52:55], s88 offen sc1
    buffer_load_dwordx4 v[100:103], v62, s[52:55], s89 offen sc1
    s_sleep 3
    buffer_load_dwordx4 v[104:107], v62, s[52:55], s88 offen sc1
    buffer_load_dwordx4 v[108:111], v62, s[52:55], s89 offen sc1
L_h2:
    s_waitcnt vmcnt(2)
    v_xor_b32 v48, s97, v96
    v_xor_b32 v49, s97, v97
    v_xor_b32 v50, s97, v98
    v_xor_b32 v51, s97, v99
    v_xor_b32 v52, s97, v100
    v_xor_b32 v53, s97, v101
    v_xor_b32 v54, s97, v102
    v_xor_b32 v55, s97, v103
    v_or3_b32 v56, v48, v49, v50
    v_or3_b32 v56, v56, v51, v52
    v_or3_b32 v56, v56, v53, v54
    v_or_b32 v56, v56, v55
    v_and_b32 v56, 1023, v56
    v_cmp_ne_u32 s[8:9], 0, v56
    s_nop 0
    s_cmp_eq_u64 s[8:9], 0
    s_nop 1
    s_cbranch_scc1 L_h2d
    buffer_load_dwordx4 v[96:99], v62, s[52:55], s88 offen sc1
    buffer_load_dwordx4 v[100:103], v62, s[52:55], s89 offen sc1
    s_waitcnt vmcnt(2)
    v_xor_b32 v48, s97, v104
    v_xor_b32 v49, s97, v105
    v_xor_b32 v50, s97, v106
    v_xor_b32 v51, s97, v107
    v_xor_b32 v52, s97, v108
    v_xor_b32 v53, s97, v109
    v_xor_b32 v54, s97, v110
    v_xor_b32 v55, s97, v111
    v_or3_b32 v56, v48, v49, v50
    v_or3_b32 v56, v56, v51, v52
    v_or3_b32 v56, v56, v53, v54
    v_or_b32 v56, v56, v55
    v_and_b32 v56, 1023, v56
    v_cmp_ne_u32 s[8:9], 0, v56
    s_nop 0
    s_cmp_eq_u64 s[8:9], 0
    s_nop 1
    s_cbranch_scc1 L_h2d
    buffer_load_dwordx4 v[104:107], v62, s[52:55], s88 offen sc1
    buffer_load_dwordx4 v[108:111], v62, s[52:55], s89 offen sc1
    s_add_u32 s36, s36, 1
    s_and_b32 s62, s36, 255
    s_cbranch_scc1 L_rs27
    s_mov_b64 exec, -1
    buffer_wbl2 sc1
    s_waitcnt vmcnt(0)
    buffer_inv sc1
    s_waitcnt vmcnt(0)
L_rs27:
    s_cmp_lt_u32 s36, 65536
    s_cbranch_scc1 L_h2
L_h2d:
    s_mov_b32 s8, 0x07060302
    v_perm_b32 v24, v49, v48, s8
    v_perm_b32 v25, v51, v50, s8
    v_perm_b32 v26, v53, v52, s8
    v_perm_b32 v27, v55, v54, s8
F_gemv:
    v_mov_b32 v59, s32
    s_waitcnt lgkmcnt(0)
    v_perm_b32 v28, v24, v24, v16
    v_perm_b32 v29, v24, v24, v18
    v_perm_b32 v30, v24, v24, v20
    v_perm_b32 v31, v24, v24, v22
    v_perm_b32 v32, v24, v24, v17
    v_perm_b32 v33, v24, v24, v19
    v_perm_b32 v34, v24, v24, v21
    v_perm_b32 v35, v24, v24, v23
    v_mfma_f32_16x16x32_bf16 v[36:39], v[28:31], v[64:67], 0
    v_perm_b32 v28, v25, v25, v16
    v_perm_b32 v29, v25, v25, v18
    v_perm_b32 v30, v25, v25, v20
    v_perm_b32 v31, v25, v25, v22
    v_mfma_f32_16x16x32_bf16 v[36:39], v[32:35], v[68:71], v[36:39]
    v_perm_b32 v32, v25, v25, v17
    v_perm_b32 v33, v25, v25, v19
    v_perm_b32 v34, v25, v25, v21
    v_perm_b32 v35, v25, v25, v23
    v_mfma_f32_16x16x32_bf16 v[36:39], v[28:31], v[72:75], v[36:39]
    v_perm_b32 v28, v26, v26, v16
    v_perm_b32 v29, v26, v26, v18
    v_perm_b32 v30, v26, v26, v20
    v_perm_b32 v31, v26, v26, v22
    v_mfma_f32_16x16x32_bf16 v[36:39], v[32:35], v[76:79], v[36:39]
    v_perm_b32 v32, v26, v26, v17
    v_perm_b32 v33, v26, v26, v19
    v_perm_b32 v34, v26, v26, v21
    v_perm_b32 v35, v26, v26, v23
    v_mfma_f32_16x16x32_bf16 v[36:39], v[28:31], v[80:83], v[36:39]
    v_perm_b32 v28, v27, v27, v16
    v_perm_b32 v29, v27, v27, v18
    v_perm_b32 v30, v27, v27, v20
    v_perm_b32 v31, v27, v27, v22
    v_mfma_f32_16x16x32_bf16 v[36:39], v[32:35], v[84:87], v[36:39]
    v_perm_b32 v32, v27, v27, v17
    v_perm_b32 v33, v27, v27, v19
    v_perm_b32 v34, v27, v27, v21
    v_perm_b32 v35, v27, v27, v23
    v_mfma_f32_16x16x32_bf16 v[36:39], v[28:31], v[88:91], v[36:39]
    s_nop 0
    v_mfma_f32_16x16x32_bf16 v[36:39], v[32:35], v[92:95], v[36:39]
L_gred:
    s_nop 7
    ds_write_b128 v8, v[36:39]
    s_mov_b64 exec, 1
    ds_add_rtn_u32 v5, v12, v59 offset:0
    s_mov_b64 exec, -1
    ds_read_b128 v[40:43], v9 offset:0
    ds_read_b128 v[44:47], v9 offset:1024
    ds_read_b128 v[48:51], v9 offset:2048
    ds_read_b128 v[52:55], v9 offset:3072
    s_waitcnt lgkmcnt(4)
    v_readfirstlane_b32 s11, v5
    s_nop 0
    s_and_b32 s11, s11, 3
    s_cmp_eq_u32 s11, 3
    s_nop 0
    s_cbranch_scc0 L_gret
    s_waitcnt lgkmcnt(2)
    v_pk_add_f32 v[40:41], v[40:41], v[44:45]
    v_pk_add_f32 v[42:43], v[42:43], v[46:47]
    s_waitcnt lgkmcnt(0)
    v_pk_add_f32 v[48:49], v[48:49], v[52:53]
    v_pk_add_f32 v[50:51], v[50:51], v[54:55]
    v_pk_add_f32 v[40:41], v[40:41], v[48:49]
    v_pk_add_f32 v[42:43], v[42:43], v[50:51]
    v_and_or_b32 v40, v40, s98, v15
    v_and_or_b32 v41, v41, s98, v15
    v_and_or_b32 v42, v42, s98, v15
    v_and_or_b32 v43, v43, s98, v15
    s_cmp_lg_u32 s38, 0
    s_cbranch_scc1 L_gsc
    buffer_store_dwordx4 v[40:43], v7, s[52:55], s10 offen
    s_nop 0
    s_setpc_b64 s[60:61]
L_gsc:
    buffer_store_dwordx4 v[40:43], v7, s[52:55], s10 offen sc1
    s_nop 0
    s_setpc_b64 s[60:61]
L_gret:
    s_waitcnt lgkmcnt(0)
    s_setpc_b64 s[60:61]
L_attn:
    s_sub_u32 s6, s3, 8
    s_mov_b32 s46, 0x2000000
    s_mov_b32 s50, 0x2000000
    s_lshl_b32 s13, s6, 14
    s_waitcnt lgkmcnt(0)
    s_mov_b32 s44, s18
    s_and_b32 s45, s19, 0xffff
    s_mov_b32 s48, s20
    s_and_b32 s49, s21, 0xffff
    s_mov_b32 s52, s40
    s_and_b32 s53, s41, 0xffff
    s_cmp_lg_u32 s6, 4
    s_cselect_b32 s39, 1, 0
    s_load_dword s96, s[40:41], 0
    s_barrier
    s_cmp_lt_u32 s6, 4
    s_cbranch_scc1 L_ainit
    s_cmp_eq_u32 s39, 0
    s_cbranch_scc1 L_acomp
    s_mov_b64 s[24:25], s[34:35]
    s_mov_b64 s[30:31], s[36:37]
    s_mov_b32 s23, 1073741824
    s_mov_b32 s10, s23
    s_mov_b32 s37, 65536
    s_mov_b32 s38, 0
    s_mov_b32 s32, 0
    s_mov_b32 s34, 1
    s_mov_b64 s[28:29], -1
    s_mov_b32 s88, s23
    s_mov_b32 s89, s23
    s_mov_b32 s90, s23
    s_mov_b32 s91, s23
    s_mov_b32 s56, s52
    s_mov_b32 s57, s53
    s_mov_b32 s58, 0
    s_mov_b32 s59, 0x20000
    v_mov_b32 v18, 0
    v_mov_b32 v7, 0
    v_mov_b32 v20, 0
    v_mov_b32 v21, 0
    v_mov_b32 v62, 0
    v_mov_b32 v60, s13
    v_mov_b32 v63, s13
    v_mov_b32 v23, s13
    v_mov_b32 v8, s13
    v_mov_b32 v9, s13
    v_add_u32 v12, 124, v4
    s_cmp_eq_u32 s6, 5
    s_cbranch_scc0 L_d6
    s_call_b64 s[60:61], F_fst
    s_call_b64 s[60:61], F_g4
    s_call_b64 s[60:61], F_gfin
    s_branch L_dd
L_d6:
    s_cmp_eq_u32 s6, 6
    s_cbranch_scc0 L_d7
    s_call_b64 s[60:61], F_fin
    s_branch L_dd
L_d7:
    s_call_b64 s[60:61], F_hop2
L_dd:
    s_mov_b64 s[34:35], s[24:25]
    s_mov_b64 s[36:37], s[30:31]
    s_waitcnt vmcnt(0) lgkmcnt(0)
L_ainit:
    s_lshl_b32 s10, s4, 22
    s_lshl_b32 s11, s5, 17
    s_add_u32 s10, s10, s11
    s_lshl_b32 s13, s6, 14
    s_and_b32 s11, s6, 3
    s_lshl_b32 s11, s11, 12
    s_add_u32 s10, s10, s11
    s_lshr_b32 s11, s6, 2
    s_lshl_b32 s11, s11, 16
    s_add_u32 s10, s10, s11
    v_xor_b32 v8, v3, v2
    v_lshlrev_b32 v8, 4, v8
    v_lshl_add_u32 v8, v2, 8, v8
    v_xor_b32 v9, 64, v8
    v_xor_b32 v10, 0x80, v8
    v_xor_b32 v11, 0xc0, v8
    v_lshlrev_b32 v7, 10, v2
    v_lshl_add_u32 v7, v3, 4, v7
    s_cmp_lt_u32 s6, 4
    s_cbranch_scc1 L_go0
    s_sub_u32 s11, s6, 3
    s_mov_b32 s63, 0
L_sp28:
    ds_read_b32 v5, v4 offset:28
    s_add_u32 s63, s63, 1
    s_waitcnt lgkmcnt(0)
    v_readfirstlane_b32 s62, v5
    s_nop 0
    s_cmp_ge_u32 s62, s11
    s_nop 1
    s_cbranch_scc1 L_sd29
    s_sleep 1
    s_cmp_lt_u32 s63, 0x200000
    s_cbranch_scc1 L_sp28
L_sd29:
    s_branch L_go
L_go0:
    s_mov_b32 s63, 0
L_sp30:
    ds_read_b32 v5, v4 offset:76
    s_add_u32 s63, s63, 1
    s_waitcnt lgkmcnt(0)
    v_readfirstlane_b32 s62, v5
    s_nop 0
    s_cmp_ge_u32 s62, 8
    s_nop 1
    s_cbranch_scc1 L_sd31
    s_sleep 1
    s_cmp_lt_u32 s63, 0x200000
    s_cbranch_scc1 L_sp30
L_sd31:
L_go:
    s_and_b32 s11, s2, 1
    s_lshr_b32 s14, s6, 2
    s_lshl_b32 s14, s14, 1
    s_add_u32 s14, s11, s14
    s_cmp_eq_u32 s14, 0
    s_cbranch_scc1 L_wa7
    s_cmp_eq_u32 s14, 1
    s_cbranch_scc1 L_wa8
L_wa0:
    s_add_u32 s12, s10, 0
    s_add_u32 m0, s13, 0
    s_nop 0
    buffer_load_dwordx4 v8, s[44:47], s12 offen offset:0 nt lds
    buffer_load_dwordx4 v9, s[44:47], s12 offen offset:1024 nt lds
    buffer_load_dwordx4 v10, s[44:47], s12 offen offset:2048 nt lds
    buffer_load_dwordx4 v11, s[44:47], s12 offen offset:3072 nt lds
    s_add_u32 s12, s10, 16384
    s_add_u32 m0, s13, 4096
    s_nop 0
    buffer_load_dwordx4 v8, s[44:47], s12 offen offset:0 nt lds
    buffer_load_dwordx4 v9, s[44:47], s12 offen offset:1024 nt lds
    buffer_load_dwordx4 v10, s[44:47], s12 offen offset:2048 nt lds
    buffer_load_dwordx4 v11, s[44:47], s12 offen offset:3072 nt lds
    s_add_u32 s12, s10, 32768
    s_add_u32 m0, s13, 8192
    s_nop 0
    buffer_load_dwordx4 v8, s[44:47], s12 offen offset:0 nt lds
    buffer_load_dwordx4 v9, s[44:47], s12 offen offset:1024 nt lds
    buffer_load_dwordx4 v10, s[44:47], s12 offen offset:2048 nt lds
    buffer_load_dwordx4 v11, s[44:47], s12 offen offset:3072 nt lds
    s_add_u32 s12, s10, 49152
    s_add_u32 m0, s13, 12288
    s_nop 0
    buffer_load_dwordx4 v8, s[44:47], s12 offen offset:0 nt lds
    buffer_load_dwordx4 v9, s[44:47], s12 offen offset:1024 nt lds
    buffer_load_dwordx4 v10, s[44:47], s12 offen offset:2048 nt lds
    buffer_load_dwordx4 v11, s[44:47], s12 offen offset:3072 nt lds
    s_add_u32 s12, s10, 0
    buffer_load_dwordx4 v[64:67], v7, s[48:51], s12 offen offset:0 nt
    buffer_load_dwordx4 v[68:71], v7, s[48:51], s12 offen offset:256 nt
    buffer_load_dwordx4 v[72:75], v7, s[48:51], s12 offen offset:512 nt
    buffer_load_dwordx4 v[76:79], v7, s[48:51], s12 offen offset:768 nt
    v_mov_b32 v5, 1
    s_mov_b64 exec, 1
    ds_add_u32 v4, v5 offset:64
    s_mov_b64 exec, -1
    s_add_u32 s12, s10, 16384
    buffer_load_dwordx4 v[80:83], v7, s[48:51], s12 offen offset:0 nt
    buffer_load_dwordx4 v[84:87], v7, s[48:51], s12 offen offset:256 nt
    buffer_load_dwordx4 v[88:91], v7, s[48:51], s12 offen offset:512 nt
    buffer_load_dwordx4 v[92:95], v7, s[48:51], s12 offen offset:768 nt
    s_branch L_wad
L_wa7:
    s_add_u32 s12, s10, 0
    s_add_u32 m0, s13, 0
    s_nop 0
    buffer_load_dwordx4 v8, s[44:47], s12 offen offset:0 nt lds
    buffer_load_dwordx4 v9, s[44:47], s12 offen offset:1024 nt lds
    buffer_load_dwordx4 v10, s[44:47], s12 offen offset:2048 nt lds
    buffer_load_dwordx4 v11, s[44:47], s12 offen offset:3072 nt lds
    s_add_u32 s12, s10, 16384
    s_add_u32 m0, s13, 4096
    s_nop 0
    buffer_load_dwordx4 v8, s[44:47], s12 offen offset:0 nt lds
    buffer_load_dwordx4 v9, s[44:47], s12 offen offset:1024 nt lds
    buffer_load_dwordx4 v10, s[44:47], s12 offen offset:2048 nt lds
    s_waitcnt vmcnt(6)
    buffer_load_dwordx4 v11, s[44:47], s12 offen offset:3072 nt lds
    s_waitcnt vmcnt(6)
    s_add_u32 s12, s10, 32768
    s_add_u32 m0, s13, 8192
    s_nop 0
    buffer_load_dwordx4 v8, s[44:47], s12 offen offset:0 nt lds
    s_waitcnt vmcnt(6)
    buffer_load_dwordx4 v9, s[44:47], s12 offen offset:1024 nt lds
    s_waitcnt vmcnt(6)
    buffer_load_dwordx4 v10, s[44:47], s12 offen offset:2048 nt lds
    s_waitcnt vmcnt(6)
    buffer_load_dwordx4 v11, s[44:47], s12 offen offset:3072 nt lds
    s_waitcnt vmcnt(6)
    s_add_u32 s12, s10, 49152
    s_add_u32 m0, s13, 12288
    s_nop 0
    buffer_load_dwordx4 v8, s[44:47], s12 offen offset:0 nt lds
    s_waitcnt vmcnt(6)
    buffer_load_dwordx4 v9, s[44:47], s12 offen offset:1024 nt lds
    s_waitcnt vmcnt(6)
    buffer_load_dwordx4 v10, s[44:47], s12 offen offset:2048 nt lds
    s_waitcnt vmcnt(6)
    buffer_load_dwordx4 v11, s[44:47], s12 offen offset:3072 nt lds
    s_waitcnt vmcnt(6)
    s_add_u32 s12, s10, 0
    buffer_load_dwordx4 v[64:67], v7, s[48:51], s12 offen offset:0 nt
    s_waitcnt vmcnt(6)
    buffer_load_dwordx4 v[68:71], v7, s[48:51], s12 offen offset:256 nt
    s_waitcnt vmcnt(6)
    buffer_load_dwordx4 v[72:75], v7, s[48:51], s12 offen offset:512 nt
    s_waitcnt vmcnt(6)
    buffer_load_dwordx4 v[76:79], v7, s[48:51], s12 offen offset:768 nt
    v_mov_b32 v5, 1
    s_mov_b64 exec, 1
    ds_add_u32 v4, v5 offset:64
    s_mov_b64 exec, -1
    s_waitcnt vmcnt(6)
    s_add_u32 s12, s10, 16384
    buffer_load_dwordx4 v[80:83], v7, s[48:51], s12 offen offset:0 nt
    s_waitcnt vmcnt(6)
    buffer_load_dwordx4 v[84:87], v7, s[48:51], s12 offen offset:256 nt
    s_waitcnt vmcnt(6)
    buffer_load_dwordx4 v[88:91], v7, s[48:51], s12 offen offset:512 nt
    s_waitcnt vmcnt(6)
    buffer_load_dwordx4 v[92:95], v7, s[48:51], s12 offen offset:768 nt
    s_waitcnt vmcnt(6)
    s_branch L_wad
L_wa8:
    s_add_u32 s12, s10, 0
    s_add_u32 m0, s13, 0
    s_nop 0
    buffer_load_dwordx4 v8, s[44:47], s12 offen offset:0 nt lds
    buffer_load_dwordx4 v9, s[44:47], s12 offen offset:1024 nt lds
    buffer_load_dwordx4 v10, s[44:47], s12 offen offset:2048 nt lds
    buffer_load_dwordx4 v11, s[44:47], s12 offen offset:3072 nt lds
    s_add_u32 s12, s10, 16384
    s_add_u32 m0, s13, 4096
    s_nop 0
    buffer_load_dwordx4 v8, s[44:47], s12 offen offset:0 nt lds
    buffer_load_dwordx4 v9, s[44:47], s12 offen offset:1024 nt lds
    buffer_load_dwordx4 v10, s[44:47], s12 offen offset:2048 nt lds
    buffer_load_dwordx4 v11, s[44:47], s12 offen offset:3072 nt lds
    s_waitcnt vmcnt(7)
    s_add_u32 s12, s10, 32768
    s_add_u32 m0, s13, 8192
    s_nop 0
    buffer_load_dwordx4 v8, s[44:47], s12 offen offset:0 nt lds
    s_waitcnt vmcnt(7)
    buffer_load_dwordx4 v9, s[44:47], s12 offen offset:1024 nt lds
    s_waitcnt vmcnt(7)
    buffer_load_dwordx4 v10, s[44:47], s12 offen offset:2048 nt lds
    s_waitcnt vmcnt(7)
    buffer_load_dwordx4 v11, s[44:47], s12 offen offset:3072 nt lds
    s_waitcnt vmcnt(7)
    s_add_u32 s12, s10, 49152
    s_add_u32 m0, s13, 12288
    s_nop 0
    buffer_load_dwordx4 v8, s[44:47], s12 offen offset:0 nt lds
    s_waitcnt vmcnt(7)
    buffer_load_dwordx4 v9, s[44:47], s12 offen offset:1024 nt lds
    s_waitcnt vmcnt(7)
    buffer_load_dwordx4 v10, s[44:47], s12 offen offset:2048 nt lds
    s_waitcnt vmcnt(7)
    buffer_load_dwordx4 v11, s[44:47], s12 offen offset:3072 nt lds
    s_waitcnt vmcnt(7)
    s_add_u32 s12, s10, 0
    buffer_load_dwordx4 v[64:67], v7, s[48:51], s12 offen offset:0 nt
    s_waitcnt vmcnt(7)
    buffer_load_dwordx4 v[68:71], v7, s[48:51], s12 offen offset:256 nt
    s_waitcnt vmcnt(7)
    buffer_load_dwordx4 v[72:75], v7, s[48:51], s12 offen offset:512 nt
    s_waitcnt vmcnt(7)
    buffer_load_dwordx4 v[76:79], v7, s[48:51], s12 offen offset:768 nt
    v_mov_b32 v5, 1
    s_mov_b64 exec, 1
    ds_add_u32 v4, v5 offset:64
    s_mov_b64 exec, -1
    s_waitcnt vmcnt(7)
    s_add_u32 s12, s10, 16384
    buffer_load_dwordx4 v[80:83], v7, s[48:51], s12 offen offset:0 nt
    s_waitcnt vmcnt(7)
    buffer_load_dwordx4 v[84:87], v7, s[48:51], s12 offen offset:256 nt
    s_waitcnt vmcnt(7)
    buffer_load_dwordx4 v[88:91], v7, s[48:51], s12 offen offset:512 nt
    s_waitcnt vmcnt(7)
    buffer_load_dwordx4 v[92:95], v7, s[48:51], s12 offen offset:768 nt
    s_waitcnt vmcnt(7)
L_wad:
    ds_read_b32 v5, v4 offset:24
    s_waitcnt lgkmcnt(0)
    v_readfirstlane_b32 s11, v5
    s_nop 0
    s_cmp_lt_u32 s11, 4
    s_nop 1
    s_cbranch_scc1 L_qlate
    s_setprio 2
    s_waitcnt vmcnt(8)
    s_call_b64 s[60:61], F_qk
    s_add_u32 s12, s10, 32768
    buffer_load_dwordx4 v[96:99], v7, s[48:51], s12 offen offset:0 nt
    buffer_load_dwordx4 v[100:103], v7, s[48:51], s12 offen offset:256 nt
    buffer_load_dwordx4 v[104:107], v7, s[48:51], s12 offen offset:512 nt
    buffer_load_dwordx4 v[108:111], v7, s[48:51], s12 offen offset:768 nt
    s_add_u32 s12, s10, 49152
    buffer_load_dwordx4 v[112:115], v7, s[48:51], s12 offen offset:0 nt
    buffer_load_dwordx4 v[116:119], v7, s[48:51], s12 offen offset:256 nt
    buffer_load_dwordx4 v[120:123], v7, s[48:51], s12 offen offset:512 nt
    buffer_load_dwordx4 v[124:127], v7, s[48:51], s12 offen offset:768 nt
    v_mov_b32 v5, 1
    s_mov_b64 exec, 1
    ds_add_u32 v4, v5 offset:28
    s_mov_b64 exec, -1
    s_branch L_qdone
L_qlate:
    s_cmp_eq_u32 s14, 0
    s_cbranch_scc1 L_wb7
    s_cmp_eq_u32 s14, 1
    s_cbranch_scc1 L_wb8
L_wb0:
    s_add_u32 s12, s10, 32768
    buffer_load_dwordx4 v[96:99], v7, s[48:51], s12 offen offset:0 nt
    buffer_load_dwordx4 v[100:103], v7, s[48:51], s12 offen offset:256 nt
    buffer_load_dwordx4 v[104:107], v7, s[48:51], s12 offen offset:512 nt
    buffer_load_dwordx4 v[108:111], v7, s[48:51], s12 offen offset:768 nt
    s_add_u32 s12, s10, 49152
    buffer_load_dwordx4 v[112:115], v7, s[48:51], s12 offen offset:0 nt
    buffer_load_dwordx4 v[116:119], v7, s[48:51], s12 offen offset:256 nt
    buffer_load_dwordx4 v[120:123], v7, s[48:51], s12 offen offset:512 nt
    buffer_load_dwordx4 v[124:127], v7, s[48:51], s12 offen offset:768 nt
    s_branch L_wbd
L_wb7:
    s_add_u32 s12, s10, 32768
    buffer_load_dwordx4 v[96:99], v7, s[48:51], s12 offen offset:0 nt
    s_waitcnt vmcnt(6)
    buffer_load_dwordx4 v[100:103], v7, s[48:51], s12 offen offset:256 nt
    s_waitcnt vmcnt(6)
    buffer_load_dwordx4 v[104:107], v7, s[48:51], s12 offen offset:512 nt
    s_waitcnt vmcnt(6)
    buffer_load_dwordx4 v[108:111], v7, s[48:51], s12 offen offset:768 nt
    s_waitcnt vmcnt(6)
    s_add_u32 s12, s10, 49152
    buffer_load_dwordx4 v[112:115], v7, s[48:51], s12 offen offset:0 nt
    s_waitcnt vmcnt(6)
    buffer_load_dwordx4 v[116:119], v7, s[48:51], s12 offen offset:256 nt
    s_waitcnt vmcnt(6)
    buffer_load_dwordx4 v[120:123], v7, s[48:51], s12 offen offset:512 nt
    s_waitcnt vmcnt(6)
    buffer_load_dwordx4 v[124:127], v7, s[48:51], s12 offen offset:768 nt
    s_branch L_wbd
L_wb8:
    s_add_u32 s12, s10, 32768
    buffer_load_dwordx4 v[96:99], v7, s[48:51], s12 offen offset:0 nt
    s_waitcnt vmcnt(7)
    buffer_load_dwordx4 v[100:103], v7, s[48:51], s12 offen offset:256 nt
    s_waitcnt vmcnt(7)
    buffer_load_dwordx4 v[104:107], v7, s[48:51], s12 offen offset:512 nt
    s_waitcnt vmcnt(7)
    buffer_load_dwordx4 v[108:111], v7, s[48:51], s12 offen offset:768 nt
    s_waitcnt vmcnt(7)
    s_add_u32 s12, s10, 49152
    buffer_load_dwordx4 v[112:115], v7, s[48:51], s12 offen offset:0 nt
    s_waitcnt vmcnt(7)
    buffer_load_dwordx4 v[116:119], v7, s[48:51], s12 offen offset:256 nt
    s_waitcnt vmcnt(7)
    buffer_load_dwordx4 v[120:123], v7, s[48:51], s12 offen offset:512 nt
    s_waitcnt vmcnt(7)
    buffer_load_dwordx4 v[124:127], v7, s[48:51], s12 offen offset:768 nt
L_wbd:
    v_mov_b32 v5, 1
    s_mov_b64 exec, 1
    ds_add_u32 v4, v5 offset:28
    s_mov_b64 exec, -1
    s_setprio 2
L_acomp:
    s_lshl_b32 s11, s39, 2
    s_mov_b32 s63, 0
L_sp32:
    ds_read_b32 v5, v4 offset:24
    s_add_u32 s63, s63, 1
    s_waitcnt lgkmcnt(0)
    v_readfirstlane_b32 s62, v5
    s_nop 0
    s_cmp_ge_u32 s62, s11
    s_nop 1
    s_cbranch_scc1 L_sd33
    s_sleep 2
    s_cmp_lt_u32 s63, 0x200000
    s_cbranch_scc1 L_sp32
L_sd33:
    s_waitcnt vmcnt(16)
    s_call_b64 s[60:61], F_qk
    s_branch L_qdone
F_qk:
    v_xor_b32 v56, v3, v2
    v_lshlrev_b32 v56, 4, v56
    v_lshl_add_u32 v56, v3, 8, v56
    v_add_u32 v56, s13, v56
    v_xor_b32 v57, 64, v56
    v_xor_b32 v58, 0x80, v56
    v_xor_b32 v59, 0xc0, v56
    v_and_b32 v6, 7, v3
    v_mul_u32_u24 v60, 272, v6
    v_lshl_add_u32 v60, v2, 4, v60
    v_add_u32 v60, 147456, v60
    ds_read_b128 v[24:27], v60 offset:0
    ds_read_b128 v[28:31], v60 offset:64
    ds_read_b128 v[32:35], v60 offset:128
    ds_read_b128 v[36:39], v60 offset:192
    ds_read_b128 v[40:43], v56
    ds_read_b128 v[44:47], v57
    ds_read_b128 v[48:51], v58
    ds_read_b128 v[52:55], v59
    s_waitcnt lgkmcnt(3)
    v_mfma_f32_16x16x32_bf16 v[8:11], v[40:43], v[24:27], 0
    ds_read_b128 v[40:43], v56 offset:4096
    s_waitcnt lgkmcnt(3)
    v_mfma_f32_16x16x32_bf16 v[8:11], v[44:47], v[28:31], v[8:11]
    ds_read_b128 v[44:47], v57 offset:4096
    s_waitcnt lgkmcnt(3)
    v_mfma_f32_16x16x32_bf16 v[8:11], v[48:51], v[32:35], v[8:11]
    ds_read_b128 v[48:51], v58 offset:4096
    s_waitcnt lgkmcnt(3)
    v_mfma_f32_16x16x32_bf16 v[8:11], v[52:55], v[36:39], v[8:11]
    ds_read_b128 v[52:55], v59 offset:4096
    s_waitcnt lgkmcnt(3)
    v_mfma_f32_16x16x32_bf16 v[12:15], v[40:43], v[24:27], 0
    ds_read_b128 v[40:43], v56 offset:8192
    s_waitcnt lgkmcnt(3)
    v_mfma_f32_16x16x32_bf16 v[12:15], v[44:47], v[28:31], v[12:15]
    ds_read_b128 v[44:47], v57 offset:8192
    s_waitcnt lgkmcnt(3)
    v_mfma_f32_16x16x32_bf16 v[12:15], v[48:51], v[32:35], v[12:15]
    ds_read_b128 v[48:51], v58 offset:8192
    s_waitcnt lgkmcnt(3)
    v_mfma_f32_16x16x32_bf16 v[12:15], v[52:55], v[36:39], v[12:15]
    ds_read_b128 v[52:55], v59 offset:8192
    s_waitcnt lgkmcnt(3)
    v_mfma_f32_16x16x32_bf16 v[16:19], v[40:43], v[24:27], 0
    ds_read_b128 v[40:43], v56 offset:12288
    s_waitcnt lgkmcnt(3)
    v_mfma_f32_16x16x32_bf16 v[16:19], v[44:47], v[28:31], v[16:19]
    ds_read_b128 v[44:47], v57 offset:12288
    s_waitcnt lgkmcnt(3)
    v_mfma_f32_16x16x32_bf16 v[16:19], v[48:51], v[32:35], v[16:19]
    ds_read_b128 v[48:51], v58 offset:12288
    s_waitcnt lgkmcnt(3)
    v_mfma_f32_16x16x32_bf16 v[16:19], v[52:55], v[36:39], v[16:19]
    ds_read_b128 v[52:55], v59 offset:12288
    s_waitcnt lgkmcnt(3)
    v_mfma_f32_16x16x32_bf16 v[20:23], v[40:43], v[24:27], 0
    s_waitcnt lgkmcnt(2)
    v_mfma_f32_16x16x32_bf16 v[20:23], v[44:47], v[28:31], v[20:23]
    s_waitcnt lgkmcnt(1)
    v_mfma_f32_16x16x32_bf16 v[20:23], v[48:51], v[32:35], v[20:23]
    s_waitcnt lgkmcnt(0)
    v_mfma_f32_16x16x32_bf16 v[20:23], v[52:55], v[36:39], v[20:23]
    s_mov_b32 s8, 0x3db504f3
    s_mov_b32 s9, 0x3fb8aa3b
    v_cvt_pk_bf16_f32 v40, v8, v9
    v_cvt_pk_bf16_f32 v41, v10, v11
    v_cvt_pk_bf16_f32 v42, v12, v13
    v_cvt_pk_bf16_f32 v43, v14, v15
    v_cvt_pk_bf16_f32 v44, v16, v17
    v_cvt_pk_bf16_f32 v45, v18, v19
    v_cvt_pk_bf16_f32 v46, v20, v21
    v_cvt_pk_bf16_f32 v47, v22, v23
    v_lshlrev_b32 v8, 16, v40
    v_and_b32 v9, s15, v40
    v_lshlrev_b32 v10, 16, v41
    v_and_b32 v11, s15, v41
    v_lshlrev_b32 v12, 16, v42
    v_and_b32 v13, s15, v42
    v_lshlrev_b32 v14, 16, v43
    v_and_b32 v15, s15, v43
    v_lshlrev_b32 v16, 16, v44
    v_and_b32 v17, s15, v44
    v_lshlrev_b32 v18, 16, v45
    v_and_b32 v19, s15, v45
    v_lshlrev_b32 v20, 16, v46
    v_and_b32 v21, s15, v46
    v_lshlrev_b32 v22, 16, v47
    v_and_b32 v23, s15, v47
    v_pk_mul_f32 v[8:9], v[8:9], s[8:9] op_sel_hi:[1,0]
    v_pk_mul_f32 v[10:11], v[10:11], s[8:9] op_sel_hi:[1,0]
    v_pk_mul_f32 v[12:13], v[12:13], s[8:9] op_sel_hi:[1,0]
    v_pk_mul_f32 v[14:15], v[14:15], s[8:9] op_sel_hi:[1,0]
    v_pk_mul_f32 v[16:17], v[16:17], s[8:9] op_sel_hi:[1,0]
    v_pk_mul_f32 v[18:19], v[18:19], s[8:9] op_sel_hi:[1,0]
    v_pk_mul_f32 v[20:21], v[20:21], s[8:9] op_sel_hi:[1,0]
    v_pk_mul_f32 v[22:23], v[22:23], s[8:9] op_sel_hi:[1,0]
    v_cvt_pk_bf16_f32 v40, v8, v9
    v_cvt_pk_bf16_f32 v41, v10, v11
    v_cvt_pk_bf16_f32 v42, v12, v13
    v_cvt_pk_bf16_f32 v43, v14, v15
    v_cvt_pk_bf16_f32 v44, v16, v17
    v_cvt_pk_bf16_f32 v45, v18, v19
    v_cvt_pk_bf16_f32 v46, v20, v21
    v_cvt_pk_bf16_f32 v47, v22, v23
    v_lshlrev_b32 v8, 16, v40
    v_and_b32 v9, s15, v40
    v_lshlrev_b32 v10, 16, v41
    v_and_b32 v11, s15, v41
    v_lshlrev_b32 v12, 16, v42
    v_and_b32 v13, s15, v42
    v_lshlrev_b32 v14, 16, v43
    v_and_b32 v15, s15, v43
    v_lshlrev_b32 v16, 16, v44
    v_and_b32 v17, s15, v44
    v_lshlrev_b32 v18, 16, v45
    v_and_b32 v19, s15, v45
    v_lshlrev_b32 v20, 16, v46
    v_and_b32 v21, s15, v46
    v_lshlrev_b32 v22, 16, v47
    v_and_b32 v23, s15, v47
    v_max3_f32 v40, v8, v9, v10
    v_max3_f32 v41, v11, v12, v13
    v_max3_f32 v40, v40, v14, v15
    v_max3_f32 v41, v41, v16, v17
    v_max3_f32 v40, v40, v18, v19
    v_max3_f32 v41, v41, v20, v21
    v_max3_f32 v40, v40, v22, v23
    v_max_f32 v40, v40, v41
    v_mov_b32 v41, v40
    s_nop 1
    v_permlane16_swap_b32 v41, v40
    v_max_f32 v40, v40, v41
    v_mov_b32 v41, v40
    s_nop 1
    v_permlane32_swap_b32 v41, v40
    v_max_f32 v40, v40, v41
    v_mul_f32 v42, s9, v40
    v_fma_f32 v8, v8, s9, -v42
    v_fma_f32 v9, v9, s9, -v42
    v_fma_f32 v10, v10, s9, -v42
    v_fma_f32 v11, v11, s9, -v42
    v_fma_f32 v12, v12, s9, -v42
    v_fma_f32 v13, v13, s9, -v42
    v_fma_f32 v14, v14, s9, -v42
    v_fma_f32 v15, v15, s9, -v42
    v_fma_f32 v16, v16, s9, -v42
    v_fma_f32 v17, v17, s9, -v42
    v_fma_f32 v18, v18, s9, -v42
    v_fma_f32 v19, v19, s9, -v42
    v_fma_f32 v20, v20, s9, -v42
    v_fma_f32 v21, v21, s9, -v42
    v_fma_f32 v22, v22, s9, -v42
    v_fma_f32 v23, v23, s9, -v42
    v_exp_f32 v8, v8
    v_exp_f32 v9, v9
    v_exp_f32 v10, v10
    v_exp_f32 v11, v11
    v_exp_f32 v12, v12
    v_exp_f32 v13, v13
    v_exp_f32 v14, v14
    v_exp_f32 v15, v15
    v_exp_f32 v16, v16
    v_exp_f32 v17, v17
    v_exp_f32 v18, v18
    v_exp_f32 v19, v19
    v_exp_f32 v20, v20
    v_exp_f32 v21, v21
    v_exp_f32 v22, v22
    v_exp_f32 v23, v23
    v_pk_add_f32 v[44:45], v[8:9], v[10:11]
    v_pk_add_f32 v[46:47], v[12:13], v[14:15]
    v_pk_add_f32 v[44:45], v[44:45], v[16:17]
    v_pk_add_f32 v[46:47], v[46:47], v[18:19]
    v_pk_add_f32 v[44:45], v[44:45], v[20:21]
    v_pk_add_f32 v[46:47], v[46:47], v[22:23]
    v_pk_add_f32 v[44:45], v[44:45], v[46:47]
    v_add_f32 v41, v44, v45
    v_cvt_pk_bf16_f32 v8, v8, v9
    v_cvt_pk_bf16_f32 v9, v10, v11
    v_cvt_pk_bf16_f32 v10, v12, v13
    v_cvt_pk_bf16_f32 v11, v14, v15
    v_cvt_pk_bf16_f32 v12, v16, v17
    v_cvt_pk_bf16_f32 v13, v18, v19
    v_cvt_pk_bf16_f32 v14, v20, v21
    v_cvt_pk_bf16_f32 v15, v22, v23
    v_mov_b32 v42, v41
    s_nop 1
    v_permlane16_swap_b32 v42, v41
    v_add_f32 v41, v41, v42
    v_mov_b32 v42, v41
    s_nop 1
    v_permlane32_swap_b32 v42, v41
    v_add_f32 v41, v41, v42
    s_lshl_b32 s11, s6, 3
    s_add_u32 s11, s11, 149632
    v_lshlrev_b32 v42, 6, v6
    v_add_u32 v42, s11, v42
    s_mov_b64 exec, 0xff
    ds_write_b64 v42, v[40:41]
    s_mov_b64 exec, -1
    v_mov_b32 v5, s39
    s_mov_b64 exec, 1
    ds_add_u32 v4, v5 offset:32
    s_mov_b64 exec, -1
    s_setpc_b64 s[60:61]
L_qdone:
    v_mul_u32_u24 v16, 528, v6
    v_lshl_add_u32 v16, v2, 7, v16
    v_add_u32 v16, s13, v16
    v_and_b32 v17, 8, v3
    v_lshl_add_u32 v16, v17, 3, v16
    s_lshr_b32 s11, s6, 2
    s_lshl_b32 s11, s11, 2
    v_add_u32 v17, s11, v4
    v_mov_b32 v18, s39
    s_mov_b32 s8, 0x05040100
    s_mov_b32 s9, 0x07060302
    s_mov_b32 s20, 0x00ff00ff
    s_mov_b32 s21, 0x00ff00ff
    s_add_u32 s97, s96, 0x1b3
    s_and_b32 s97, s97, 1023
    s_mov_b32 s98, 0xfffffc00
    v_mov_b32 v19, s97
    s_getreg_b32 s33, hwreg(HW_REG_XCC_ID)
    s_and_b32 s33, s33, 15
    s_lshl_b32 s33, s33, 16
    s_mov_b32 s31, 0x3fb8aa3b
    s_lshr_b32 s19, s5, 2
    s_cmp_lt_u32 s6, 6
    s_cbranch_scc1 L_rsd
    v_lshrrev_b32 v22, 3, v1
    v_and_b32 v5, 7, v1
    v_lshlrev_b32 v21, 4, v5
    v_lshl_add_u32 v21, v22, 13, v21
    v_lshlrev_b32 v23, 3, v1
    v_add_u32 v23, 150912, v23
    v_lshrrev_b32 v20, 5, v1
    v_lshlrev_b32 v20, 2, v20
    v_lshl_add_u32 v20, v5, 3, v20
    s_lshl_b32 s10, s4, 8
    s_and_b32 s11, s19, 3
    s_lshl_b32 s11, s11, 6
    s_add_u32 s10, s10, s11
    s_lshr_b32 s11, s19, 2
    s_lshl_b32 s11, s11, 11
    s_add_u32 s23, s10, s11
    s_mov_b32 s56, s36
    s_and_b32 s57, s37, 0xffff
    s_mov_b32 s58, 4096
    s_mov_b32 s59, 0x20000
    s_cmp_eq_u32 s6, 6
    s_cselect_b32 s28, s34, s16
    s_cselect_b32 s29, s35, s17
    s_cselect_b32 s10, s10, s23
    s_mov_b32 s11, 327680
    s_cselect_b32 s11, 819200, s11
    s_mov_b32 s12, 196608
    s_cselect_b32 s12, 163840, s12
    s_add_u32 s28, s28, s10
    s_addc_u32 s29, s29, 0
    s_lshl_b32 s10, s4, 10
    s_add_u32 s10, s10, s11
    s_lshl_b32 s11, s19, 7
    s_add_u32 s88, s10, s11
    s_add_u32 s89, s88, 0x10000
    s_add_u32 s90, s88, 0x20000
    s_add_u32 s91, s88, s12
    s_mov_b32 s34, 0
    s_mov_b32 s38, 0
    s_mov_b32 s37, 0
L_rsd:
    v_cndmask_b32 v40, v8, 0, s[20:21]
    v_cndmask_b32 v41, v9, 0, s[20:21]
    v_cndmask_b32 v42, v10, 0, s[20:21]
    v_cndmask_b32 v43, v11, 0, s[20:21]
    v_cndmask_b32 v44, v12, 0, s[20:21]
    v_cndmask_b32 v45, v13, 0, s[20:21]
    v_cndmask_b32 v46, v14, 0, s[20:21]
    v_cndmask_b32 v47, v15, 0, s[20:21]
    v_cndmask_b32 v8, 0, v8, s[20:21]
    v_cndmask_b32 v9, 0, v9, s[20:21]
    v_cndmask_b32 v10, 0, v10, s[20:21]
    v_cndmask_b32 v11, 0, v11, s[20:21]
    v_cndmask_b32 v12, 0, v12, s[20:21]
    v_cndmask_b32 v13, 0, v13, s[20:21]
    v_cndmask_b32 v14, 0, v14, s[20:21]
    v_cndmask_b32 v15, 0, v15, s[20:21]
    s_waitcnt vmcnt(8)
    v_perm_b32 v56, v68, v64, s8
    v_perm_b32 v57, v76, v72, s8
    v_perm_b32 v58, v84, v80, s8
    v_perm_b32 v59, v92, v88, s8
    v_perm_b32 v60, v68, v64, s9
    v_perm_b32 v61, v76, v72, s9
    v_perm_b32 v62, v84, v80, s9
    v_perm_b32 v63, v92, v88, s9
    v_mfma_f32_16x16x32_bf16 v[24:27], v[56:59], v[8:11], 0
    v_perm_b32 v56, v69, v65, s8
    v_perm_b32 v57, v77, v73, s8
    v_perm_b32 v58, v85, v81, s8
    v_perm_b32 v59, v93, v89, s8
    v_mfma_f32_16x16x32_bf16 v[28:31], v[60:63], v[8:11], 0
    v_perm_b32 v60, v69, v65, s9
    v_perm_b32 v61, v77, v73, s9
    v_perm_b32 v62, v85, v81, s9
    v_perm_b32 v63, v93, v89, s9
    v_mfma_f32_16x16x32_bf16 v[32:35], v[56:59], v[8:11], 0
    v_perm_b32 v56, v70, v66, s8
    v_perm_b32 v57, v78, v74, s8
    v_perm_b32 v58, v86, v82, s8
    v_perm_b32 v59, v94, v90, s8
    v_mfma_f32_16x16x32_bf16 v[36:39], v[60:63], v[8:11], 0
    v_perm_b32 v60, v70, v66, s9
    v_perm_b32 v61, v78, v74, s9
    v_perm_b32 v62, v86, v82, s9
    v_perm_b32 v63, v94, v90, s9
    v_mfma_f32_16x16x32_bf16 v[24:27], v[56:59], v[40:43], v[24:27]
    v_perm_b32 v56, v71, v67, s8
    v_perm_b32 v57, v79, v75, s8
    v_perm_b32 v58, v87, v83, s8
    v_perm_b32 v59, v95, v91, s8
    v_mfma_f32_16x16x32_bf16 v[28:31], v[60:63], v[40:43], v[28:31]
    v_perm_b32 v60, v71, v67, s9
    v_perm_b32 v61, v79, v75, s9
    v_perm_b32 v62, v87, v83, s9
    v_perm_b32 v63, v95, v91, s9
    v_mfma_f32_16x16x32_bf16 v[32:35], v[56:59], v[40:43], v[32:35]
    s_nop 0
    v_mfma_f32_16x16x32_bf16 v[36:39], v[60:63], v[40:43], v[36:39]
    s_waitcnt vmcnt(6)
    v_perm_b32 v64, v100, v96, s8
    v_perm_b32 v68, v100, v96, s9
    v_perm_b32 v72, v101, v97, s8
    v_perm_b32 v76, v101, v97, s9
    v_perm_b32 v80, v102, v98, s8
    v_perm_b32 v84, v102, v98, s9
    v_perm_b32 v88, v103, v99, s8
    v_perm_b32 v92, v103, v99, s9
    s_waitcnt vmcnt(4)
    v_perm_b32 v65, v108, v104, s8
    v_perm_b32 v69, v108, v104, s9
    v_perm_b32 v73, v109, v105, s8
    v_perm_b32 v77, v109, v105, s9
    v_perm_b32 v81, v110, v106, s8
    v_perm_b32 v85, v110, v106, s9
    v_perm_b32 v89, v111, v107, s8
    v_perm_b32 v93, v111, v107, s9
    s_waitcnt vmcnt(2)
    v_perm_b32 v66, v116, v112, s8
    v_perm_b32 v70, v116, v112, s9
    v_perm_b32 v74, v117, v113, s8
    v_perm_b32 v78, v117, v113, s9
    v_perm_b32 v82, v118, v114, s8
    v_perm_b32 v86, v118, v114, s9
    v_perm_b32 v90, v119, v115, s8
    v_perm_b32 v94, v119, v115, s9
    s_waitcnt vmcnt(0)
    v_perm_b32 v67, v124, v120, s8
    v_perm_b32 v83, v126, v122, s8
    v_perm_b32 v71, v124, v120, s9
    v_mfma_f32_16x16x32_bf16 v[24:27], v[64:67], v[12:15], v[24:27]
    v_perm_b32 v87, v126, v122, s9
    v_mfma_f32_16x16x32_bf16 v[24:27], v[80:83], v[44:47], v[24:27]
    v_perm_b32 v75, v125, v121, s8
    v_mfma_f32_16x16x32_bf16 v[28:31], v[68:71], v[12:15], v[28:31]
    v_perm_b32 v91, v127, v123, s8
    v_mfma_f32_16x16x32_bf16 v[28:31], v[84:87], v[44:47], v[28:31]
    v_perm_b32 v79, v125, v121, s9
    v_mfma_f32_16x16x32_bf16 v[32:35], v[72:75], v[12:15], v[32:35]
    v_perm_b32 v95, v127, v123, s9
    v_mfma_f32_16x16x32_bf16 v[32:35], v[88:91], v[44:47], v[32:35]
    v_mfma_f32_16x16x32_bf16 v[36:39], v[76:79], v[12:15], v[36:39]
    v_mfma_f32_16x16x32_bf16 v[36:39], v[92:95], v[44:47], v[36:39]
    ds_write_b128 v16, v[24:27] offset:0
    s_nop 0
    ds_write_b128 v16, v[28:31] offset:16
    s_nop 2
    ds_write_b128 v16, v[32:35] offset:32
    s_nop 0
    ds_write_b128 v16, v[36:39] offset:48
    s_mov_b64 exec, 1
    ds_add_u32 v17, v18 offset:36
    s_mov_b64 exec, -1
    s_mul_i32 s18, s6, s39
    s_cmp_lt_u32 s18, 4
    s_cbranch_scc1 L_reducer
    v_mov_b32 v15, v19
    s_cmp_lt_u32 s6, 6
    s_cbranch_scc1 L_fin
    s_and_b32 s11, s5, 3
    s_cmp_eq_u32 s11, 1
    s_cbranch_scc1 L_n4
    s_branch L_fin
L_n4:
    global_load_dword v44, v20, s[28:29]
    v_mov_b32 v40, 1.0
    v_mov_b32 v41, 1.0
    v_mov_b32 v42, 1.0
    v_mov_b32 v43, 1.0
    s_cmp_eq_u32 s6, 6
    s_cbranch_scc0 L_n6
    s_mov_b32 exec_hi, 0
    v_mov_b32 v43, 0
    s_mov_b64 exec, -1
    s_mov_b32 s63, 0
L_sp34:
    ds_read_b32 v5, v4 offset:44
    s_add_u32 s63, s63, 1
    s_waitcnt lgkmcnt(0)
    v_readfirstlane_b32 s62, v5
    s_nop 0
    s_cmp_ge_u32 s62, 1
    s_nop 1
    s_cbranch_scc1 L_sd35
    s_sleep 2
    s_cmp_lt_u32 s63, 0x200000
    s_cbranch_scc1 L_sp34
L_sd35:
    s_call_b64 s[60:61], F_g4
    s_call_b64 s[60:61], F_gfin
    s_branch L_fin
L_n6:
    s_mov_b32 s38, 1
    s_mov_b32 s63, 0
L_sp36:
    ds_read_b32 v5, v4 offset:44
    s_add_u32 s63, s63, 1
    s_waitcnt lgkmcnt(0)
    v_readfirstlane_b32 s62, v5
    s_nop 0
    s_cmp_ge_u32 s62, 1
    s_nop 1
    s_cbranch_scc1 L_sd37
    s_sleep 1
    s_cmp_lt_u32 s63, 0x200000
    s_cbranch_scc1 L_sp36
L_sd37:
    s_call_b64 s[60:61], F_fin
    s_cmp_lg_u32 s2, 8
    s_cbranch_scc1 L_fin
    s_add_u32 s96, s96, 1
    v_mov_b32 v28, s96
    v_mov_b32 v29, 0
    s_mov_b64 exec, 1
    buffer_store_dword v28, v29, s[52:55], 0 offen sc1
    s_mov_b64 exec, -1
    s_branch L_fin
F_wst:
    ds_read_b128 v[24:27], v7 offset:0
    ds_read_b128 v[28:31], v7 offset:16
    ds_read_b128 v[32:35], v7 offset:32
    ds_read_b128 v[36:39], v7 offset:48
    s_waitcnt lgkmcnt(0)
    v_max3_f32 v52, v24, v26, v28
    v_max3_f32 v52, v52, v30, v32
    v_max3_f32 v52, v52, v34, v36
    v_max_f32 v52, v52, v38
    v_mul_f32 v56, s31, v52
    v_fma_f32 v40, v24, s31, -v56
    v_fma_f32 v41, v26, s31, -v56
    v_fma_f32 v42, v28, s31, -v56
    v_fma_f32 v43, v30, s31, -v56
    v_fma_f32 v44, v32, s31, -v56
    v_fma_f32 v45, v34, s31, -v56
    v_fma_f32 v46, v36, s31, -v56
    v_fma_f32 v47, v38, s31, -v56
    v_exp_f32 v40, v40
    v_exp_f32 v41, v41
    v_exp_f32 v42, v42
    v_exp_f32 v43, v43
    v_exp_f32 v44, v44
    v_exp_f32 v45, v45
    v_exp_f32 v46, v46
    v_exp_f32 v47, v47
    v_mul_f32 v53, v40, v25
    v_fmac_f32 v53, v41, v27
    v_fmac_f32 v53, v42, v29
    v_fmac_f32 v53, v43, v31
    v_fmac_f32 v53, v44, v33
    v_fmac_f32 v53, v45, v35
    v_fmac_f32 v53, v46, v37
    v_fmac_f32 v53, v47, v39
    s_nop 0
    s_setpc_b64 s[60:61]
L_reducer:
    s_cmp_ge_u32 s18, 2
    s_cbranch_scc1 L_h1
    s_setprio 3
    v_lshlrev_b32 v13, 6, v6
    v_add_u32 v13, 149632, v13
    v_lshlrev_b32 v20, 3, v6
    v_add_u32 v20, 151936, v20
    v_lshlrev_b32 v22, 5, v6
    v_add_u32 v22, 152000, v22
    v_lshrrev_b32 v6, 5, v1
    s_lshl_b32 s11, s18, 2
    v_add_u32 v6, s11, v6
    v_lshlrev_b32 v14, 5, v6
    v_add_u32 v14, 152000, v14
    v_and_b32 v8, 31, v1
    v_mul_u32_u24 v9, 528, v6
    v_lshl_add_u32 v9, v8, 4, v9
    v_lshlrev_b32 v10, 9, v6
    v_lshl_add_u32 v10, v8, 4, v10
    v_lshlrev_b32 v11, 4, v1
    s_lshl_b32 s12, s4, 5
    s_add_u32 s12, s12, s5
    s_lshl_b32 s13, s12, 7
    s_add_u32 s13, s13, 4096
    s_lshl_b32 s12, s12, 12
    s_add_u32 s12, s12, 1048576
    v_or_b32 v54, s33, v19
    v_mov_b32 v55, v19
    v_lshlrev_b32 v21, 4, v8
    v_add_u32 v21, 151424, v21
    s_bitcmp1_b32 s5, 2
    s_cselect_b32 s28, 0, -1
    s_cselect_b32 s29, -1, 0
    s_lshr_b32 s11, s5, 3
    s_lshl_b32 s14, s18, 1
    s_sub_u32 s11, s11, s14
    s_cmp_eq_u32 s11, 0
    s_cselect_b64 s[26:27], s[28:29], 0
    s_cmp_eq_u32 s11, 1
    s_cselect_b64 s[28:29], s[28:29], 0
    s_lshl_b32 s20, s39, 3
    s_lshl_b32 s21, s39, 2
    s_mul_i32 s22, s39, 3
    s_cmp_lg_u32 s18, 0
    s_cbranch_scc1 L_nostp
    s_mov_b32 s63, 0
L_sp38:
    ds_read_b32 v5, v4 offset:32
    s_add_u32 s63, s63, 1
    s_waitcnt lgkmcnt(0)
    v_readfirstlane_b32 s62, v5
    s_nop 0
    s_cmp_ge_u32 s62, s20
    s_nop 1
    s_cbranch_scc1 L_sd39
    s_sleep 1
    s_cmp_lt_u32 s63, 0x200000
    s_cbranch_scc1 L_sp38
L_sd39:
    v_mov_b32 v7, v13
    s_nop 0
    s_call_b64 s[60:61], F_wst
    v_and_or_b32 v52, v52, s98, v55
    v_and_or_b32 v53, v53, s98, v55
    s_mov_b64 exec, 0xff
    s_cmp_eq_u32 s39, 0
    s_cbranch_scc1 L_sk1
    buffer_store_dwordx4 v[52:55], v11, s[52:55], s13 offen
L_sk1:
    ds_write_b64 v20, v[52:53]
    ds_write_b128 v22, v[40:43]
    ds_write_b128 v22, v[44:47] offset:16
    s_mov_b64 exec, -1
    v_mov_b32 v5, s39
    ds_max_u32 v4, v5 offset:68
L_nostp:
    s_mov_b32 s63, 0
L_sp40:
    ds_read_b32 v5, v4 offset:68
    s_add_u32 s63, s63, 1
    s_waitcnt lgkmcnt(0)
    v_readfirstlane_b32 s62, v5
    s_nop 0
    s_cmp_ge_u32 s62, s39
    s_nop 1
    s_cbranch_scc1 L_sd41
    s_sleep 1
    s_cmp_lt_u32 s63, 0x200000
    s_cbranch_scc1 L_sp40
L_sd41:
    ds_read_b128 v[40:43], v14
    ds_read_b128 v[44:47], v14 offset:16
    ds_read_b128 v[96:99], v14 offset:64
    ds_read_b128 v[100:103], v14 offset:80
    v_mov_b32 v48, 0
    v_mov_b32 v104, 0
    v_mov_b32 v49, 0
    v_mov_b32 v105, 0
    v_mov_b32 v50, 0
    v_mov_b32 v106, 0
    v_mov_b32 v51, 0
    v_mov_b32 v107, 0
    v_mov_b32 v17, v4
    s_mov_b32 s14, 0
L_ored:
    s_mov_b32 s63, 0
L_sp42:
    ds_read_b32 v5, v17 offset:36
    s_add_u32 s63, s63, 1
    s_waitcnt lgkmcnt(0)
    v_readfirstlane_b32 s62, v5
    s_nop 0
    s_cmp_ge_u32 s62, s22
    s_nop 1
    s_cbranch_scc1 L_sd43
    s_cmp_lt_u32 s63, 0x200000
    s_cbranch_scc1 L_sp42
L_sd43:
L_ofs:
    s_waitcnt lgkmcnt(0)
    ds_read_b32 v5, v17 offset:36
    ds_read_b128 v[64:67], v9 offset:0
    ds_read_b128 v[68:71], v9 offset:16384
    ds_read_b128 v[72:75], v9 offset:32768
    ds_read_b128 v[76:79], v9 offset:49152
    ds_read_b128 v[80:83], v9 offset:1056
    ds_read_b128 v[84:87], v9 offset:17440
    ds_read_b128 v[88:91], v9 offset:33824
    ds_read_b128 v[92:95], v9 offset:50208
    s_add_u32 s63, s63, 1
    s_waitcnt lgkmcnt(8)
    v_readfirstlane_b32 s62, v5
    s_nop 0
    s_cmp_ge_u32 s62, s21
    s_nop 1
    s_cbranch_scc1 L_ofd
    s_cmp_lt_u32 s63, 0x200000
    s_cbranch_scc1 L_ofs
L_ofd:
    s_waitcnt lgkmcnt(7)
    v_pk_fma_f32 v[48:49], v[64:65], v[40:41], v[48:49] op_sel_hi:[1,0,1]
    v_pk_fma_f32 v[50:51], v[66:67], v[40:41], v[50:51] op_sel_hi:[1,0,1]
    s_waitcnt lgkmcnt(6)
    v_pk_fma_f32 v[48:49], v[68:69], v[40:41], v[48:49] op_sel:[0,1,0] op_sel_hi:[1,1,1]
    v_pk_fma_f32 v[50:51], v[70:71], v[40:41], v[50:51] op_sel:[0,1,0] op_sel_hi:[1,1,1]
    s_waitcnt lgkmcnt(5)
    v_pk_fma_f32 v[48:49], v[72:73], v[42:43], v[48:49] op_sel_hi:[1,0,1]
    v_pk_fma_f32 v[50:51], v[74:75], v[42:43], v[50:51] op_sel_hi:[1,0,1]
    s_waitcnt lgkmcnt(4)
    v_pk_fma_f32 v[48:49], v[76:77], v[42:43], v[48:49] op_sel:[0,1,0] op_sel_hi:[1,1,1]
    v_pk_fma_f32 v[50:51], v[78:79], v[42:43], v[50:51] op_sel:[0,1,0] op_sel_hi:[1,1,1]
    s_cmp_eq_u32 s14, 0
    s_cbranch_scc1 L_sk2
    v_and_or_b32 v48, v48, s98, v55
    v_and_or_b32 v49, v49, s98, v55
    v_and_or_b32 v50, v50, s98, v55
    v_and_or_b32 v51, v51, s98, v55
    s_cmp_eq_u32 s39, 0
    s_cbranch_scc1 L_sk2
    buffer_store_dwordx4 v[48:51], v10, s[52:55], s12 offen
L_sk2:
    s_waitcnt lgkmcnt(3)
    v_pk_fma_f32 v[104:105], v[80:81], v[96:97], v[104:105] op_sel_hi:[1,0,1]
    v_pk_fma_f32 v[106:107], v[82:83], v[96:97], v[106:107] op_sel_hi:[1,0,1]
    s_waitcnt lgkmcnt(2)
    v_pk_fma_f32 v[104:105], v[84:85], v[96:97], v[104:105] op_sel:[0,1,0] op_sel_hi:[1,1,1]
    v_pk_fma_f32 v[106:107], v[86:87], v[96:97], v[106:107] op_sel:[0,1,0] op_sel_hi:[1,1,1]
    s_waitcnt lgkmcnt(1)
    v_pk_fma_f32 v[104:105], v[88:89], v[98:99], v[104:105] op_sel_hi:[1,0,1]
    v_pk_fma_f32 v[106:107], v[90:91], v[98:99], v[106:107] op_sel_hi:[1,0,1]
    s_waitcnt lgkmcnt(0)
    v_pk_fma_f32 v[104:105], v[92:93], v[98:99], v[104:105] op_sel:[0,1,0] op_sel_hi:[1,1,1]
    v_pk_fma_f32 v[106:107], v[94:95], v[98:99], v[106:107] op_sel:[0,1,0] op_sel_hi:[1,1,1]
    s_cmp_eq_u32 s14, 1
    s_cbranch_scc1 L_oredd
    s_mov_b32 s14, 1
    v_add_u32 v17, 4, v17
    v_add_u32 v9, 0x10000, v9
    v_mov_b32 v40, v44
    v_mov_b32 v96, v100
    v_mov_b32 v41, v45
    v_mov_b32 v97, v101
    v_mov_b32 v42, v46
    v_mov_b32 v98, v102
    v_mov_b32 v43, v47
    v_mov_b32 v99, v103
    s_nop 0
    s_branch L_ored
L_oredd:
    v_and_or_b32 v104, v104, s98, v55
    v_and_or_b32 v105, v105, s98, v55
    v_and_or_b32 v106, v106, s98, v55
    v_and_or_b32 v107, v107, s98, v55
    s_cmp_eq_u32 s39, 0
    s_cbranch_scc1 L_sk3
    buffer_store_dwordx4 v[104:107], v10, s[52:55], s12 offen offset:1024
L_sk3:
    s_or_b64 s[8:9], s[26:27], s[28:29]
    s_cbranch_scc0 L_noown
    v_cndmask_b32 v56, v104, v48, s[26:27]
    v_cndmask_b32 v57, v105, v49, s[26:27]
    v_cndmask_b32 v58, v106, v50, s[26:27]
    v_cndmask_b32 v59, v107, v51, s[26:27]
    v_and_b32 v56, s98, v56
    v_and_b32 v57, s98, v57
    v_and_b32 v58, s98, v58
    v_and_b32 v59, s98, v59
    s_mov_b64 exec, s[8:9]
    ds_write_b128 v21, v[56:59]
    s_mov_b64 exec, -1
    v_mov_b32 v5, s39
    ds_max_u32 v4, v5 offset:92
L_noown:
    s_cmp_lg_u32 s39, 0
    s_cbranch_scc1 L_fin
    s_mov_b32 s39, 1
    s_setprio 0
    s_branch L_ainit
L_h1:
    v_mov_b32 v15, v19
    v_lshlrev_b32 v7, 4, v1
    s_mov_b32 s34, 1
    v_and_b32 v61, 31, v1
    v_lshlrev_b32 v61, 7, v61
    v_lshrrev_b32 v63, 3, v1
    v_and_b32 v5, 7, v1
    v_lshlrev_b32 v60, 4, v5
    v_lshl_add_u32 v62, v63, 12, v60
    s_cmp_eq_u32 s6, 2
    s_cbranch_scc1 L_a2
    s_lshl_b32 s11, s6, 1
    s_lshr_b32 s25, 0x3600, s11
    s_xor_b32 s25, s25, s5
    s_and_b32 s25, s25, 3
    s_lshl_b32 s25, s25, 7
    s_add_u32 s11, s25, 151424
    v_add_u32 v60, s11, v60
    v_lshlrev_b32 v63, 2, v63
    v_add_u32 v63, 150656, v63
    s_lshl_b32 s10, s4, 17
    s_lshl_b32 s11, s19, 9
    s_add_u32 s10, s10, s11
    s_add_u32 s10, s10, s25
    s_add_u32 s88, s10, 1048576
    s_add_u32 s89, s10, 1081344
    s_add_u32 s90, s10, 1114112
    s_add_u32 s91, s10, 1146880
    s_and_b32 s23, s4, 3
    s_lshl_b32 s23, s23, 13
    s_lshl_b32 s11, s19, 10
    s_add_u32 s23, s23, s11
    s_lshr_b32 s11, s4, 2
    s_lshl_b32 s11, s11, 9
    s_add_u32 s23, s23, s11
    s_add_u32 s23, s23, s25
    s_add_u32 s23, s23, 2129920
    s_and_b32 s11, s5, 7
    s_lshl_b32 s11, s11, 3
    s_mov_b64 s[92:93], 0xff
    s_lshl_b64 s[92:93], s[92:93], s11
    s_lshr_b32 s24, s5, 3
    s_cmp_eq_u32 s24, 0
    s_cselect_b64 s[26:27], s[92:93], 0
    s_not_b64 s[16:17], s[26:27]
    s_cmp_eq_u32 s24, 1
    s_cselect_b64 s[28:29], s[92:93], 0
    s_not_b64 s[18:19], s[28:29]
    s_cmp_eq_u32 s24, 2
    s_cselect_b64 s[12:13], s[92:93], 0
    s_not_b64 s[20:21], s[12:13]
    s_cmp_eq_u32 s24, 3
    s_cselect_b64 s[42:43], s[92:93], 0
    s_not_b64 s[94:95], s[42:43]
    s_mov_b32 s63, 0
L_sp44:
    ds_read_b32 v5, v4 offset:28
    s_add_u32 s63, s63, 1
    s_waitcnt lgkmcnt(0)
    v_readfirstlane_b32 s62, v5
    s_nop 0
    s_cmp_ge_u32 s62, 8
    s_nop 1
    s_cbranch_scc1 L_sd45
    s_sleep 2
    s_cmp_lt_u32 s63, 0x200000
    s_cbranch_scc1 L_sp44
L_sd45:
    s_mov_b32 s36, 0
    s_mov_b64 s[8:9], -1
    s_mov_b32 s24, 0
L_o1:
    s_cmp_eq_u64 s[8:9], 0
    s_cbranch_scc1 L_o1n
    s_mov_b64 exec, s[16:17]
    s_cbranch_execz L_o1l0
    buffer_load_dwordx4 v[24:27], v62, s[52:55], s88 offen sc1
L_o1l0:
    s_mov_b64 exec, s[18:19]
    s_cbranch_execz L_o1l1
    buffer_load_dwordx4 v[28:31], v62, s[52:55], s89 offen sc1
L_o1l1:
    s_mov_b64 exec, s[20:21]
    s_cbranch_execz L_o1l2
    buffer_load_dwordx4 v[32:35], v62, s[52:55], s90 offen sc1
L_o1l2:
    s_mov_b64 exec, s[94:95]
    s_cbranch_execz L_o1l3
    buffer_load_dwordx4 v[36:39], v62, s[52:55], s91 offen sc1
L_o1l3:
    s_add_u32 s36, s36, 1
    s_mov_b64 s[8:9], 0
    s_waitcnt vmcnt(0)
L_o1n:
    s_mov_b64 exec, -1
    ds_read_b64 v[54:55], v4 offset:88
    ds_read2_b32 v[40:41], v63 offset0:0 offset1:8
    ds_read2_b32 v[42:43], v63 offset0:16 offset1:24
    s_mov_b64 exec, s[26:27]
    ds_read_b128 v[24:27], v60
    s_mov_b64 exec, s[28:29]
    ds_read_b128 v[28:31], v60
    s_mov_b64 exec, s[12:13]
    ds_read_b128 v[32:35], v60
    s_mov_b64 exec, s[42:43]
    ds_read_b128 v[36:39], v60
L_o1h:
    s_mov_b64 exec, s[16:17]
    s_cbranch_execz L_o1k0
    v_xor_b32 v24, s97, v24
    v_xor_b32 v25, s97, v25
    v_xor_b32 v26, s97, v26
    v_xor_b32 v27, s97, v27
    v_or3_b32 v56, v24, v25, v26
    v_or_b32 v56, v56, v27
    v_and_b32 v56, 1023, v56
    v_cmp_ne_u32 s[16:17], 0, v56
    s_nop 0
    s_or_b64 s[8:9], s[8:9], s[16:17]
L_o1k0:
    s_mov_b64 exec, s[18:19]
    s_nop 0
    s_cbranch_execz L_o1k1
    v_xor_b32 v28, s97, v28
    v_xor_b32 v29, s97, v29
    v_xor_b32 v30, s97, v30
    v_xor_b32 v31, s97, v31
    v_or3_b32 v56, v28, v29, v30
    v_or_b32 v56, v56, v31
    v_and_b32 v56, 1023, v56
    v_cmp_ne_u32 s[18:19], 0, v56
    s_nop 0
    s_or_b64 s[8:9], s[8:9], s[18:19]
L_o1k1:
    s_mov_b64 exec, s[20:21]
    s_nop 0
    s_cbranch_execz L_o1k2
    v_xor_b32 v32, s97, v32
    v_xor_b32 v33, s97, v33
    v_xor_b32 v34, s97, v34
    v_xor_b32 v35, s97, v35
    v_or3_b32 v56, v32, v33, v34
    v_or_b32 v56, v56, v35
    v_and_b32 v56, 1023, v56
    v_cmp_ne_u32 s[20:21], 0, v56
    s_nop 0
    s_or_b64 s[8:9], s[8:9], s[20:21]
L_o1k2:
    s_mov_b64 exec, s[94:95]
    s_nop 0
    s_cbranch_execz L_o1k3
    v_xor_b32 v36, s97, v36
    v_xor_b32 v37, s97, v37
    v_xor_b32 v38, s97, v38
    v_xor_b32 v39, s97, v39
    v_or3_b32 v56, v36, v37, v38
    v_or_b32 v56, v56, v39
    v_and_b32 v56, 1023, v56
    v_cmp_ne_u32 s[94:95], 0, v56
    s_nop 0
    s_or_b64 s[8:9], s[8:9], s[94:95]
L_o1k3:
    s_mov_b64 exec, -1
    s_waitcnt lgkmcnt(0)
    v_and_b32 v54, v54, v55
    s_add_u32 s63, s63, 1
    v_readfirstlane_b32 s24, v54
L_o1i:
    s_cmp_eq_u64 s[8:9], 0
    s_cselect_b32 s11, s24, 0
    s_cmp_lg_u32 s11, 0
    s_nop 0
    s_cbranch_scc1 L_o1d
    s_cmp_eq_u64 s[8:9], 0
    s_cbranch_scc1 L_o1s
    s_and_b32 s62, s36, 255
    s_cbranch_scc1 L_rs46
    s_mov_b64 exec, -1
    buffer_wbl2 sc1
    s_waitcnt vmcnt(0)
    buffer_inv sc1
    s_waitcnt vmcnt(0)
L_rs46:
    s_cmp_lt_u32 s36, 65536
    s_cbranch_scc1 L_o1
    s_branch L_o1d
L_o1s:
    s_cmp_lt_u32 s63, 0x200000
    s_cbranch_scc1 L_o1
L_o1d:
    s_call_b64 s[60:61], L_g4d
    v_mov_b32 v5, 1
    s_mov_b64 exec, 1
    ds_add_u32 v4, v5 offset:44
    s_mov_b64 exec, -1
    s_branch L_fin
L_a2:
    v_lshlrev_b32 v63, 2, v1
    v_add_u32 v63, 150656, v63
    s_lshl_b32 s28, 1, s5
    s_mov_b32 s29, s28
    s_lshl_b32 s30, s4, 12
    s_lshl_b32 s11, s19, 4
    s_add_u32 s30, s30, s11
    s_add_u32 s30, s30, 4096
    s_lshl_b32 s11, s19, 3
    s_add_u32 s11, s11, 151936
    v_mov_b32 v60, s11
    s_mov_b32 s38, 1
    s_mov_b32 s63, 0
L_sp47:
    ds_read_b32 v5, v4 offset:28
    s_add_u32 s63, s63, 1
    s_waitcnt lgkmcnt(0)
    v_readfirstlane_b32 s62, v5
    s_nop 0
    s_cmp_ge_u32 s62, 8
    s_nop 1
    s_cbranch_scc1 L_sd48
    s_sleep 2
    s_cmp_lt_u32 s63, 0x200000
    s_cbranch_scc1 L_sp47
L_sd48:
    s_mov_b32 s36, 0
    s_not_b64 s[8:9], s[28:29]
L_stp:
    s_mov_b64 exec, s[8:9]
    buffer_load_dwordx4 v[56:59], v61, s[52:55], s30 offen sc1
    s_add_u32 s36, s36, 1
    s_waitcnt vmcnt(0)
    v_xor_b32 v56, s97, v56
    v_xor_b32 v57, s97, v57
    v_xor_b32 v58, s97, v58
    v_xor_b32 v59, s97, v59
    v_or3_b32 v48, v56, v57, v58
    v_or_b32 v48, v48, v59
    v_and_b32 v48, 1023, v48
    v_cmp_ne_u32 s[8:9], 0, v48
    s_nop 0
    s_cmp_eq_u64 s[8:9], 0
    s_nop 1
    s_cbranch_scc1 L_stpd
    s_and_b32 s62, s36, 255
    s_cbranch_scc1 L_rs49
    s_mov_b64 exec, -1
    buffer_wbl2 sc1
    s_waitcnt vmcnt(0)
    buffer_inv sc1
    s_waitcnt vmcnt(0)
L_rs49:
    s_cmp_lt_u32 s36, 65536
    s_cbranch_scc1 L_stp
L_stpd:
    s_mov_b64 exec, -1
    s_call_b64 s[60:61], F_fst
    s_cmp_eq_u64 s[8:9], 0
    s_cbranch_scc1 L_fin
    s_setprio 0
    s_mov_b32 s63, 0
L_sp50:
    ds_read_b32 v5, v4 offset:52
    s_add_u32 s63, s63, 1
    s_waitcnt lgkmcnt(0)
    v_readfirstlane_b32 s62, v5
    s_nop 0
    s_cmp_ge_u32 s62, 4
    s_nop 1
    s_cbranch_scc1 L_sd51
    s_sleep 8
    s_cmp_lt_u32 s63, 0x200000
    s_cbranch_scc1 L_sp50
L_sd51:
    s_mov_b32 s63, 0
L_sp52:
    ds_read_b32 v5, v4 offset:72
    s_add_u32 s63, s63, 1
    s_waitcnt lgkmcnt(0)
    v_readfirstlane_b32 s62, v5
    s_nop 0
    s_cmp_ge_u32 s62, 4
    s_nop 1
    s_cbranch_scc1 L_sd53
    s_sleep 8
    s_cmp_lt_u32 s63, 0x200000
    s_cbranch_scc1 L_sp52
L_sd53:
    s_sleep 127
    s_sleep 127
    s_sleep 127
    s_sleep 127
    buffer_wbl2 sc1
    s_waitcnt vmcnt(0)
L_fin:
L_end:
    s_endpgm
.fill (20480 - (. - recurrent_scan__gqa_block_cached__mixer_channel_mlp__decode_kernel)) / 4, 4, 0xbf810000
.section .rodata,"a"
.p2align 6
.amdhsa_kernel recurrent_scan__gqa_block_cached__mixer_channel_mlp__decode_kernel
.amdhsa_next_free_vgpr 128
.amdhsa_next_free_sgpr 102
.amdhsa_accum_offset 128
.amdhsa_group_segment_fixed_size 0
.amdhsa_kernarg_size 104
.amdhsa_user_sgpr_count 2
.amdhsa_user_sgpr_kernarg_segment_ptr 1
.amdhsa_system_sgpr_workgroup_id_x 1
.amdhsa_float_denorm_mode_32 3
.end_amdhsa_kernel
```
